```python
import torch

def _softmax(x, axis=-1):
    return torch.softmax(x, dim=axis)

def _gelu(x):
    return torch.nn.functional.gelu(x, approximate='tanh')

def _silu(x):
    return torch.nn.functional.silu(x)

def _sigmoid(x):
    return torch.sigmoid(x)

def _layernorm(x, axis=-1, eps=1e-05):
    m = x.mean(dim=axis, keepdim=True)
    v = x.var(dim=axis, keepdim=True, unbiased=False)
    return (x - m) / torch.sqrt(v + eps)

def _scatter_add(tgt, idx, src, axis=0):
    return tgt.clone().index_add_(axis, idx, src)

def _segment_sum(src, seg, n):
    out = torch.zeros((n,) + src.shape[1:], dtype=src.dtype)
    return out.index_add_(0, seg, src)

def _pad(x, pw):
    flat = tuple((v for pair in reversed(pw) for v in pair))
    return torch.nn.functional.pad(x, flat)
kernel_name = 'adaLN_cond__mha_block_cached__glu_gated_glu__decode'

def setup_inputs():

    _w = lambda a: (lambda t: t.to(torch.bfloat16) if t.is_floating_point() else t)(torch.as_tensor(a))

    def _A_setup():
        B, Sq, D = (1, 1, 576)
        H, Sk, Dh = (32, 8192, 128)
        return {'x': _w((lambda *s: torch.randn(*s, dtype=torch.bfloat16) * 0.05)(B, Sq, D)), 'k_cache': _w((lambda *s: torch.randn(*s, dtype=torch.bfloat16) * 3.2)(B, H, Sk, Dh)), 'v_cache': _w((lambda *s: torch.randn(*s, dtype=torch.bfloat16) * 0.4)(B, H, Sk, Dh)), 'wq': _w((lambda *s: torch.randn(*s, dtype=torch.bfloat16) * 3.2)(D, H * Dh) * D ** (-0.5)), 'wo': _w((lambda *s: torch.randn(*s, dtype=torch.bfloat16) * 0.4)(H * Dh, D) * (H * Dh) ** (-0.5))}
    _A_in = _A_setup()

    def _B_setup():
        B, S, D, F = (1, 1, 576, 4608)
        return {'x': _w((lambda *s: torch.randn(*s, dtype=torch.bfloat16) * 0.05)(B, S, D)), 'w_gate': _w((lambda *s: torch.randn(*s, dtype=torch.bfloat16) * 0.05)(D, F)), 'w_up': _w((lambda *s: torch.randn(*s, dtype=torch.bfloat16) * 0.05)(D, F)), 'w_down': _w((lambda *s: torch.randn(*s, dtype=torch.bfloat16) * 0.05)(F, D))}
    _B_in = _B_setup()
    return {'A_x': _A_in['x'], 'A_k_cache': _A_in['k_cache'], 'A_v_cache': _A_in['v_cache'], 'A_wq': _A_in['wq'], 'A_wo': _A_in['wo'], 'B_x': _B_in['x'], 'B_w_gate': _B_in['w_gate'], 'B_w_up': _B_in['w_up'], 'B_w_down': _B_in['w_down'], 'c': _w((lambda *s: torch.randn(*s, dtype=torch.bfloat16) * 0.2)(1, 576) * 8.0), 'w_mod': _w((lambda *s: torch.randn(*s, dtype=torch.bfloat16) * 0.2)(576, 6 * 576) * 576 ** (-0.5) * 8.0)}

def reference(A_x, A_k_cache, A_v_cache, A_wq, A_wo, B_x, B_w_gate, B_w_up, B_w_down, c, w_mod):

    def _A_ref(x, k_cache, v_cache, wq, wo):
        B, Sq, D = x.shape
        H, Dh = (32, 128)
        q = (lambda x, *d: x.permute(*d))((x @ wq).reshape(B, Sq, H, Dh), 0, 2, 1, 3)
        scores = torch.einsum('bhqd,bhkd->bhqk', q, k_cache) * Dh ** (-0.5)
        p = _softmax(scores, axis=-1)
        o = torch.einsum('bhqk,bhkd->bhqd', p, v_cache)
        return (lambda x, *d: x.permute(*d))(o, 0, 2, 1, 3).reshape(B, Sq, H * Dh) @ wo

    def _B_ref(x, w_gate, w_up, w_down):
        g = torch.einsum('bsd,df->bsf', x, w_gate)
        u = torch.einsum('bsd,df->bsf', x, w_up)
        h = _sigmoid(g) * u
        return torch.einsum('bsf,fd->bsd', h, w_down)
    x = A_x
    mod = (_silu(c) @ w_mod).reshape(c.shape[0], 6, 1, -1)
    sa, ca, ga, sb, cb, gb = (mod[:, 0].clone(), mod[:, 1].clone(), mod[:, 2].clone(), mod[:, 3].clone(), mod[:, 4].clone(), mod[:, 5].clone())
    h = _layernorm(x, axis=-1) * (1 + ca) + sa
    x = x + ga * _A_ref(h, A_k_cache, A_v_cache, A_wq, A_wo)
    h = _layernorm(x, axis=-1) * (1 + cb) + sb
    x = x + gb * _B_ref(h, B_w_gate, B_w_up, B_w_down)
    return x
```

```asm
; @launch grid=(256,1,1) block=(512,1,1) lds=163840
.amdgcn_target "amdgcn-amd-amdhsa--gfx950"
.text
.globl adaLN_cond__mha_block_cached__glu_gated_glu__decode_kernel
.p2align 8
.type adaLN_cond__mha_block_cached__glu_gated_glu__decode_kernel,@function
adaLN_cond__mha_block_cached__glu_gated_glu__decode_kernel:
    s_cmp_ge_u32 s2, 256
    s_cbranch_scc1 Lend
    s_load_dwordx16 s[8:23], s[0:1], 0
    s_load_dwordx8 s[24:31], s[0:1], 64
    s_load_dwordx4 s[32:35], s[0:1], 96
    v_lshrrev_b32 v1, 6, v0
    v_and_b32 v0, 63, v0
    v_readfirstlane_b32 s3, v1
    s_and_b32 s4, s2, 7
    s_lshr_b32 s5, s2, 3
    s_lshl_b32 s100, s4, 2
    s_add_u32 s100, s100, s5
    s_and_b32 s100, s100, 31
    s_mov_b32 s52, 0
    s_mov_b32 s53, 0
    s_mov_b32 s54, 0
    s_cmp_ge_u32 s4, 6
    s_cbranch_scc0 Le_lazy
    s_lshl_b32 s55, s5, 1
    s_add_u32 s55, s55, s4
    s_sub_u32 s55, s55, 6
    s_cmp_lt_u32 s55, 54
    s_cbranch_scc0 Le_done
    s_mov_b32 s52, 1
    s_mul_i32 s53, s55, 43
    s_lshr_b32 s53, s53, 8
    s_mul_i32 s54, s53, 6
    s_sub_u32 s54, s55, s54
    s_branch Le_done
Le_lazy:
Le_done:
    s_mov_b32 s72, 0
    s_mov_b32 s73, 0
    s_mov_b32 s74, 0
    s_mov_b32 s75, 135168
    s_cmp_ge_u32 s100, 18
    s_cbranch_scc0 Le_done2
    s_sub_u32 s55, s100, 18
    s_lshl_b32 s55, s55, 3
    s_add_u32 s55, s55, s4
    s_cmp_lt_u32 s55, 108
    s_cbranch_scc0 Le_done2
    s_mov_b32 s72, 1
    s_mul_i32 s73, s55, 43
    s_lshr_b32 s73, s73, 8
    s_mul_i32 s74, s73, 6
    s_sub_u32 s74, s55, s74
    s_add_u32 s73, s73, 9
    s_cmp_ge_u32 s4, 6
    s_cselect_b32 s75, 110592, s75
Le_done2:
    s_waitcnt lgkmcnt(0)
    s_load_dword s7, s[34:35], 0
    s_cmp_lt_u32 s3, 4
    s_cbranch_scc0 Lnonstream
    v_lshlrev_b32 v2, 4, v0
    s_lshl_b32 s56, s3, 10
    v_add_u32 v2, s56, v2
    s_lshl_b32 s56, s2, 18
    s_add_u32 s36, s10, s56
    s_addc_u32 s37, s11, 0
    s_and_b32 s37, s37, 0xffff
    s_mov_b32 s38, 0x40000
    s_mov_b32 s39, 0x20000
    s_add_u32 s40, s12, s56
    s_addc_u32 s41, s13, 0
    s_and_b32 s41, s41, 0xffff
    s_mov_b32 s42, 0x40000
    s_mov_b32 s43, 0x20000
    v_bfe_u32 v8, v0, 1, 2
    v_bfe_u32 v9, v0, 4, 1
    v_xor_b32 v8, v8, v9
    s_and_b32 s57, s3, 1
    s_lshl_b32 s57, s57, 1
    v_xor_b32 v8, s57, v8
    v_lshlrev_b32 v8, 5, v8
    v_and_b32 v7, 1, v0
    v_lshl_add_u32 v8, v7, 4, v8
    v_lshrrev_b32 v9, 3, v0
    s_cmp_ge_u32 s4, 6
    s_cbranch_scc0 Ls_wq
    s_cmp_eq_u32 s52, 1
    s_cbranch_scc0 Ls_front_done
    s_mov_b32 s44, s28
    s_and_b32 s45, s29, 0xffff
    s_mov_b32 s46, 3981312
    s_mov_b32 s47, 0x20000
    s_mov_b32 s61, 6912
    v_mul_lo_u32 v4, v9, s61
    v_add_u32 v4, v4, v8
    s_mul_i32 s60, s54, 663552
    s_lshl_b32 s61, s53, 8
    s_add_u32 s60, s60, s61
    s_mul_i32 s61, s3, 55296
    s_add_u32 s60, s60, s61
    s_lshl_b32 s62, s3, 10
    s_add_u32 s62, s62, 135168
    s_mov_b32 m0, s62
    s_nop 0
    buffer_load_dwordx4 v4, s[44:47], s60 offen nt lds
    s_add_u32 s62, s62, 4096
    s_add_u32 s60, s60, 221184
    s_mov_b32 m0, s62
    s_nop 0
    buffer_load_dwordx4 v4, s[44:47], s60 offen nt lds
    s_add_u32 s62, s62, 4096
    s_add_u32 s60, s60, 221184
    s_mov_b32 m0, s62
    s_nop 0
    buffer_load_dwordx4 v4, s[44:47], s60 offen nt lds
    s_add_u32 s62, s62, 4096
    s_sub_u32 s60, s60, 442240
    s_mov_b32 m0, s62
    s_nop 0
    buffer_load_dwordx4 v4, s[44:47], s60 offen nt lds
    s_add_u32 s62, s62, 4096
    s_add_u32 s60, s60, 221184
    s_mov_b32 m0, s62
    s_nop 0
    buffer_load_dwordx4 v4, s[44:47], s60 offen nt lds
    s_add_u32 s62, s62, 4096
    s_add_u32 s60, s60, 221184
    s_mov_b32 m0, s62
    s_nop 0
    buffer_load_dwordx4 v4, s[44:47], s60 offen nt lds
    s_add_u32 s62, s62, 4096
    s_branch Ls_front_done
Ls_wq:
    s_mov_b32 s48, s14
    s_and_b32 s49, s15, 0xffff
    s_mov_b32 s50, 4718592
    s_mov_b32 s51, 0x20000
    s_mov_b32 s61, 8192
    v_mul_lo_u32 v4, v9, s61
    v_add_u32 v4, v4, v8
    s_mul_i32 s60, s4, 786432
    s_lshl_b32 s61, s5, 8
    s_add_u32 s60, s60, s61
    s_mul_i32 s61, s3, 65536
    s_add_u32 s60, s60, s61
    s_lshl_b32 s62, s3, 10
    s_add_u32 s62, s62, 110592
    s_mov_b32 m0, s62
    s_nop 0
    buffer_load_dwordx4 v4, s[48:51], s60 offen nt lds
    s_add_u32 s62, s62, 4096
    s_add_u32 s60, s60, 262144
    s_mov_b32 m0, s62
    s_nop 0
    buffer_load_dwordx4 v4, s[48:51], s60 offen nt lds
    s_add_u32 s62, s62, 4096
    s_add_u32 s60, s60, 262144
    s_mov_b32 m0, s62
    s_nop 0
    buffer_load_dwordx4 v4, s[48:51], s60 offen nt lds
    s_add_u32 s62, s62, 4096
    s_sub_u32 s60, s60, 524160
    s_mov_b32 m0, s62
    s_nop 0
    buffer_load_dwordx4 v4, s[48:51], s60 offen nt lds
    s_add_u32 s62, s62, 4096
    s_add_u32 s60, s60, 262144
    s_mov_b32 m0, s62
    s_nop 0
    buffer_load_dwordx4 v4, s[48:51], s60 offen nt lds
    s_add_u32 s62, s62, 4096
    s_add_u32 s60, s60, 262144
    s_mov_b32 m0, s62
    s_nop 0
    buffer_load_dwordx4 v4, s[48:51], s60 offen nt lds
    s_add_u32 s62, s62, 4096
Ls_front_done:
    s_mov_b32 s63, 0
    buffer_load_dwordx4 v[64:67], v2, s[36:39], s63 offen nt
    s_add_u32 s63, s63, 4096
    buffer_load_dwordx4 v[68:71], v2, s[36:39], s63 offen nt
    s_add_u32 s63, s63, 4096
    buffer_load_dwordx4 v[72:75], v2, s[36:39], s63 offen nt
    s_add_u32 s63, s63, 4096
    buffer_load_dwordx4 v[76:79], v2, s[36:39], s63 offen nt
    s_add_u32 s63, s63, 4096
    s_barrier
    v_mov_b32 v10, 159744
    v_mov_b32 v11, 1
    s_waitcnt vmcnt(4)
    s_mov_b64 exec, 1
    ds_add_u32 v10, v11
    s_mov_b64 exec, -1
    s_waitcnt vmcnt(5)
    buffer_load_dwordx4 v[80:83], v2, s[36:39], s63 offen nt
    s_add_u32 s63, s63, 4096
    s_waitcnt vmcnt(5)
    buffer_load_dwordx4 v[84:87], v2, s[36:39], s63 offen nt
    s_add_u32 s63, s63, 4096
    s_waitcnt vmcnt(5)
    buffer_load_dwordx4 v[88:91], v2, s[36:39], s63 offen nt
    s_add_u32 s63, s63, 4096
    s_waitcnt vmcnt(5)
    buffer_load_dwordx4 v[92:95], v2, s[36:39], s63 offen nt
    s_add_u32 s63, s63, 4096
    s_waitcnt vmcnt(5)
    buffer_load_dwordx4 v[96:99], v2, s[36:39], s63 offen nt
    s_add_u32 s63, s63, 4096
    s_waitcnt vmcnt(5)
    buffer_load_dwordx4 v[100:103], v2, s[36:39], s63 offen nt
    s_add_u32 s63, s63, 4096
    s_waitcnt vmcnt(5)
    buffer_load_dwordx4 v[104:107], v2, s[36:39], s63 offen nt
    s_add_u32 s63, s63, 4096
    s_waitcnt vmcnt(5)
    buffer_load_dwordx4 v[108:111], v2, s[36:39], s63 offen nt
    s_add_u32 s63, s63, 4096
    s_waitcnt vmcnt(5)
    buffer_load_dwordx4 v[112:115], v2, s[36:39], s63 offen nt
    s_add_u32 s63, s63, 4096
    s_waitcnt vmcnt(5)
    buffer_load_dwordx4 v[116:119], v2, s[36:39], s63 offen nt
    s_add_u32 s63, s63, 4096
    s_waitcnt vmcnt(5)
    buffer_load_dwordx4 v[120:123], v2, s[36:39], s63 offen nt
    s_add_u32 s63, s63, 4096
    s_waitcnt vmcnt(5)
    buffer_load_dwordx4 v[124:127], v2, s[36:39], s63 offen nt
    s_add_u32 s63, s63, 4096
    s_waitcnt vmcnt(5)
    buffer_load_dwordx4 v[128:131], v2, s[36:39], s63 offen nt
    s_add_u32 s63, s63, 4096
    s_waitcnt vmcnt(5)
    buffer_load_dwordx4 v[132:135], v2, s[36:39], s63 offen nt
    s_add_u32 s63, s63, 4096
    s_waitcnt vmcnt(5)
    buffer_load_dwordx4 v[136:139], v2, s[36:39], s63 offen nt
    s_add_u32 s63, s63, 4096
    s_waitcnt vmcnt(5)
    buffer_load_dwordx4 v[140:143], v2, s[36:39], s63 offen nt
    s_add_u32 s63, s63, 4096
    s_waitcnt vmcnt(5)
    buffer_load_dwordx4 v[144:147], v2, s[36:39], s63 offen nt
    s_add_u32 s63, s63, 4096
    s_waitcnt vmcnt(5)
    buffer_load_dwordx4 v[148:151], v2, s[36:39], s63 offen nt
    s_add_u32 s63, s63, 4096
    s_waitcnt vmcnt(5)
    buffer_load_dwordx4 v[152:155], v2, s[36:39], s63 offen nt
    s_add_u32 s63, s63, 4096
    s_waitcnt vmcnt(5)
    buffer_load_dwordx4 v[156:159], v2, s[36:39], s63 offen nt
    s_add_u32 s63, s63, 4096
    s_waitcnt vmcnt(5)
    buffer_load_dwordx4 v[160:163], v2, s[36:39], s63 offen nt
    s_add_u32 s63, s63, 4096
    s_waitcnt vmcnt(5)
    buffer_load_dwordx4 v[164:167], v2, s[36:39], s63 offen nt
    s_add_u32 s63, s63, 4096
    s_waitcnt vmcnt(5)
    buffer_load_dwordx4 v[168:171], v2, s[36:39], s63 offen nt
    s_add_u32 s63, s63, 4096
    s_waitcnt vmcnt(5)
    buffer_load_dwordx4 v[172:175], v2, s[36:39], s63 offen nt
    s_add_u32 s63, s63, 4096
    s_waitcnt vmcnt(5)
    buffer_load_dwordx4 v[176:179], v2, s[36:39], s63 offen nt
    s_add_u32 s63, s63, 4096
    s_mov_b64 exec, 1
    ds_add_u32 v10, v11 offset:8
    s_mov_b64 exec, -1
    s_waitcnt vmcnt(5)
    buffer_load_dwordx4 v[180:183], v2, s[36:39], s63 offen nt
    s_add_u32 s63, s63, 4096
    s_waitcnt vmcnt(5)
    buffer_load_dwordx4 v[184:187], v2, s[36:39], s63 offen nt
    s_add_u32 s63, s63, 4096
    s_waitcnt vmcnt(5)
    buffer_load_dwordx4 v[188:191], v2, s[36:39], s63 offen nt
    s_mov_b32 s63, 0
    s_waitcnt vmcnt(5)
    buffer_load_dwordx4 v[192:195], v2, s[40:43], s63 offen nt
    s_add_u32 s63, s63, 4096
    s_waitcnt vmcnt(5)
    buffer_load_dwordx4 v[196:199], v2, s[40:43], s63 offen nt
    s_add_u32 s63, s63, 4096
    s_waitcnt vmcnt(5)
    buffer_load_dwordx4 v[200:203], v2, s[40:43], s63 offen nt
    s_add_u32 s63, s63, 4096
    s_waitcnt vmcnt(5)
    buffer_load_dwordx4 v[204:207], v2, s[40:43], s63 offen nt
    s_add_u32 s63, s63, 4096
    s_waitcnt vmcnt(5)
    buffer_load_dwordx4 v[208:211], v2, s[40:43], s63 offen nt
    s_add_u32 s63, s63, 4096
    s_waitcnt vmcnt(5)
    buffer_load_dwordx4 v[212:215], v2, s[40:43], s63 offen nt
    s_add_u32 s63, s63, 4096
    s_waitcnt vmcnt(5)
    buffer_load_dwordx4 v[216:219], v2, s[40:43], s63 offen nt
    s_add_u32 s63, s63, 4096
    s_waitcnt vmcnt(5)
    buffer_load_dwordx4 v[220:223], v2, s[40:43], s63 offen nt
    s_add_u32 s63, s63, 4096
    s_waitcnt vmcnt(5)
    buffer_load_dwordx4 v[224:227], v2, s[40:43], s63 offen nt
    s_add_u32 s63, s63, 4096
    s_waitcnt vmcnt(5)
    buffer_load_dwordx4 v[228:231], v2, s[40:43], s63 offen nt
    s_add_u32 s63, s63, 4096
    s_waitcnt vmcnt(5)
    buffer_load_dwordx4 v[232:235], v2, s[40:43], s63 offen nt
    s_add_u32 s63, s63, 4096
    s_waitcnt vmcnt(5)
    buffer_load_dwordx4 v[236:239], v2, s[40:43], s63 offen nt
    s_add_u32 s63, s63, 4096
    s_waitcnt vmcnt(5)
    buffer_load_dwordx4 v[240:243], v2, s[40:43], s63 offen nt
    s_add_u32 s63, s63, 4096
    s_waitcnt vmcnt(5)
    buffer_load_dwordx4 v[244:247], v2, s[40:43], s63 offen nt
    s_add_u32 s63, s63, 4096
    s_waitcnt vmcnt(5)
    buffer_load_dwordx4 v[248:251], v2, s[40:43], s63 offen nt
    s_add_u32 s63, s63, 4096
    s_waitcnt vmcnt(5)
    buffer_load_dwordx4 v[252:255], v2, s[40:43], s63 offen nt
    s_add_u32 s63, s63, 4096
    v_and_b32 v12, 15, v0
    v_and_b32 v13, 1, v0
    v_mov_b32 v14, 0xffff
    v_mov_b32 v15, 0xffff0000
    v_cmp_eq_u32 vcc, 1, v13
    s_nop 1
    v_cndmask_b32 v14, v14, v15, vcc
    v_lshrrev_b32 v12, 1, v12
    v_cmp_eq_u32 vcc, 0, v12
    s_nop 1
    v_cndmask_b32 v16, 0, v14, vcc
    v_cmp_eq_u32 vcc, 1, v12
    s_nop 1
    v_cndmask_b32 v17, 0, v14, vcc
    v_cmp_eq_u32 vcc, 2, v12
    s_nop 1
    v_cndmask_b32 v18, 0, v14, vcc
    v_cmp_eq_u32 vcc, 3, v12
    s_nop 1
    v_cndmask_b32 v19, 0, v14, vcc
    v_and_b32 v12, 15, v0
    v_lshlrev_b32 v12, 4, v12
    v_add_u32 v12, 160192, v12
    v_and_b32 v13, 2, v0
    v_cmp_ne_u32 s[66:67], 0, v13
    v_and_b32 v13, 1, v0
    v_cmp_ne_u32 s[68:69], 0, v13
    s_mov_b32 s70, 0x3db504f3
    s_mov_b32 s71, 0x3fb8aa3b
    s_mov_b32 s59, 0
Ls_wq_flag:
    s_add_u32 s59, s59, 1
    s_cmp_lt_u32 s59, 0x1000000
    s_cbranch_scc0 Lend
    ds_read_b32 v13, v10 offset:12
    s_waitcnt lgkmcnt(0)
    v_readfirstlane_b32 s56, v13
    s_nop 0
    s_cmp_eq_u32 s56, 0
    s_cbranch_scc1 Ls_wq_flag
    ds_read_b128 v[20:23], v12
    s_waitcnt lgkmcnt(0)
    s_add_u32 s7, s7, 1
    s_and_b32 s6, s7, 0xfff
    s_lshl_b32 s58, s5, 21
    s_add_u32 s44, s10, s58
    s_addc_u32 s45, s11, 0
    s_and_b32 s45, s45, 0xffff
    s_mov_b32 s46, 0x200000
    s_mov_b32 s47, 0x20000
    s_add_u32 s48, s12, s58
    s_addc_u32 s49, s13, 0
    s_and_b32 s49, s49, 0xffff
    s_mov_b32 s50, 0x200000
    s_mov_b32 s51, 0x20000
    s_lshl_b32 s58, s5, 8
    s_add_u32 s58, s58, 851968
    s_add_u32 s56, s34, s58
    s_addc_u32 s57, s35, 0
    v_lshlrev_b32 v3, 4, v0
    v_dot2_f32_bf16 v32, v64, v20, 0
    v_dot2_f32_bf16 v32, v65, v21, v32
    v_dot2_f32_bf16 v32, v66, v22, v32
    v_dot2_f32_bf16 v32, v67, v23, v32
    s_waitcnt vmcnt(5)
    buffer_load_dwordx4 v[64:67], v2, s[40:43], s63 offen nt
    s_add_u32 s63, s63, 4096
    v_dot2_f32_bf16 v33, v68, v20, 0
    v_dot2_f32_bf16 v33, v69, v21, v33
    v_dot2_f32_bf16 v33, v70, v22, v33
    v_dot2_f32_bf16 v33, v71, v23, v33
    s_waitcnt vmcnt(5)
    buffer_load_dwordx4 v[68:71], v2, s[40:43], s63 offen nt
    s_add_u32 s63, s63, 4096
    v_dot2_f32_bf16 v34, v72, v20, 0
    v_dot2_f32_bf16 v34, v73, v21, v34
    v_dot2_f32_bf16 v34, v74, v22, v34
    v_dot2_f32_bf16 v34, v75, v23, v34
    s_waitcnt vmcnt(5)
    buffer_load_dwordx4 v[72:75], v2, s[40:43], s63 offen nt
    s_add_u32 s63, s63, 4096
    v_dot2_f32_bf16 v35, v76, v20, 0
    v_dot2_f32_bf16 v35, v77, v21, v35
    v_dot2_f32_bf16 v35, v78, v22, v35
    v_dot2_f32_bf16 v35, v79, v23, v35
    s_waitcnt vmcnt(5)
    buffer_load_dwordx4 v[76:79], v2, s[40:43], s63 offen nt
    s_add_u32 s63, s63, 4096
    v_dot2_f32_bf16 v36, v80, v20, 0
    v_dot2_f32_bf16 v36, v81, v21, v36
    v_dot2_f32_bf16 v36, v82, v22, v36
    v_dot2_f32_bf16 v36, v83, v23, v36
    v_dot2_f32_bf16 v37, v84, v20, 0
    v_dot2_f32_bf16 v37, v85, v21, v37
    v_dot2_f32_bf16 v37, v86, v22, v37
    v_dot2_f32_bf16 v37, v87, v23, v37
    s_waitcnt vmcnt(5)
    buffer_load_dwordx4 v[80:83], v2, s[40:43], s63 offen nt
    s_add_u32 s63, s63, 4096
    v_dot2_f32_bf16 v38, v88, v20, 0
    v_dot2_f32_bf16 v38, v89, v21, v38
    v_dot2_f32_bf16 v38, v90, v22, v38
    v_dot2_f32_bf16 v38, v91, v23, v38
    v_dot2_f32_bf16 v39, v92, v20, 0
    v_dot2_f32_bf16 v39, v93, v21, v39
    v_dot2_f32_bf16 v39, v94, v22, v39
    v_dot2_f32_bf16 v39, v95, v23, v39
    v_dot2_f32_bf16 v40, v96, v20, 0
    v_dot2_f32_bf16 v40, v97, v21, v40
    v_dot2_f32_bf16 v40, v98, v22, v40
    v_dot2_f32_bf16 v40, v99, v23, v40
    s_waitcnt vmcnt(5)
    buffer_load_dwordx4 v[84:87], v2, s[40:43], s63 offen nt
    s_add_u32 s63, s63, 4096
    s_mov_b32 s76, 1
    s_atomic_add s76, s[56:57], 0 glc
    v_dot2_f32_bf16 v41, v100, v20, 0
    v_dot2_f32_bf16 v41, v101, v21, v41
    v_dot2_f32_bf16 v41, v102, v22, v41
    v_dot2_f32_bf16 v41, v103, v23, v41
    v_dot2_f32_bf16 v42, v104, v20, 0
    v_dot2_f32_bf16 v42, v105, v21, v42
    v_dot2_f32_bf16 v42, v106, v22, v42
    v_dot2_f32_bf16 v42, v107, v23, v42
    v_dot2_f32_bf16 v43, v108, v20, 0
    v_dot2_f32_bf16 v43, v109, v21, v43
    v_dot2_f32_bf16 v43, v110, v22, v43
    v_dot2_f32_bf16 v43, v111, v23, v43
    s_waitcnt vmcnt(5)
    buffer_load_dwordx4 v[88:91], v2, s[40:43], s63 offen nt
    s_add_u32 s63, s63, 4096
    v_dot2_f32_bf16 v44, v112, v20, 0
    v_dot2_f32_bf16 v44, v113, v21, v44
    v_dot2_f32_bf16 v44, v114, v22, v44
    v_dot2_f32_bf16 v44, v115, v23, v44
    v_dot2_f32_bf16 v45, v116, v20, 0
    v_dot2_f32_bf16 v45, v117, v21, v45
    v_dot2_f32_bf16 v45, v118, v22, v45
    v_dot2_f32_bf16 v45, v119, v23, v45
    v_dot2_f32_bf16 v46, v120, v20, 0
    v_dot2_f32_bf16 v46, v121, v21, v46
    v_dot2_f32_bf16 v46, v122, v22, v46
    v_dot2_f32_bf16 v46, v123, v23, v46
    s_waitcnt vmcnt(5)
    buffer_load_dwordx4 v[92:95], v2, s[40:43], s63 offen nt
    s_add_u32 s63, s63, 4096
    v_dot2_f32_bf16 v47, v124, v20, 0
    v_dot2_f32_bf16 v47, v125, v21, v47
    v_dot2_f32_bf16 v47, v126, v22, v47
    v_dot2_f32_bf16 v47, v127, v23, v47
    v_add_f32_dpp v32, v32, v32 row_ror:8 row_mask:0xf bank_mask:0x3
    v_add_f32_dpp v33, v33, v33 row_ror:8 row_mask:0xf bank_mask:0x3
    v_add_f32_dpp v34, v34, v34 row_ror:8 row_mask:0xf bank_mask:0x3
    v_add_f32_dpp v35, v35, v35 row_ror:8 row_mask:0xf bank_mask:0x3
    v_add_f32_dpp v36, v36, v36 row_ror:8 row_mask:0xf bank_mask:0x3
    v_add_f32_dpp v37, v37, v37 row_ror:8 row_mask:0xf bank_mask:0x3
    v_add_f32_dpp v38, v38, v38 row_ror:8 row_mask:0xf bank_mask:0x3
    v_add_f32_dpp v39, v39, v39 row_ror:8 row_mask:0xf bank_mask:0x3
    v_add_f32_dpp v32, v40, v40 row_ror:8 row_mask:0xf bank_mask:0xc
    v_add_f32_dpp v33, v41, v41 row_ror:8 row_mask:0xf bank_mask:0xc
    v_add_f32_dpp v34, v42, v42 row_ror:8 row_mask:0xf bank_mask:0xc
    v_add_f32_dpp v35, v43, v43 row_ror:8 row_mask:0xf bank_mask:0xc
    v_add_f32_dpp v36, v44, v44 row_ror:8 row_mask:0xf bank_mask:0xc
    v_add_f32_dpp v37, v45, v45 row_ror:8 row_mask:0xf bank_mask:0xc
    v_add_f32_dpp v38, v46, v46 row_ror:8 row_mask:0xf bank_mask:0xc
    v_add_f32_dpp v39, v47, v47 row_ror:8 row_mask:0xf bank_mask:0xc
    v_add_f32_dpp v32, v32, v32 row_half_mirror row_mask:0xf bank_mask:0x5
    v_add_f32_dpp v33, v33, v33 row_half_mirror row_mask:0xf bank_mask:0x5
    v_add_f32_dpp v34, v34, v34 row_half_mirror row_mask:0xf bank_mask:0x5
    v_add_f32_dpp v35, v35, v35 row_half_mirror row_mask:0xf bank_mask:0x5
    v_add_f32_dpp v32, v36, v36 row_half_mirror row_mask:0xf bank_mask:0xa
    v_add_f32_dpp v33, v37, v37 row_half_mirror row_mask:0xf bank_mask:0xa
    v_add_f32_dpp v34, v38, v38 row_half_mirror row_mask:0xf bank_mask:0xa
    v_add_f32_dpp v35, v39, v39 row_half_mirror row_mask:0xf bank_mask:0xa
    v_add_f32_dpp v40, v32, v32 quad_perm:[2,3,0,1] row_mask:0xf bank_mask:0xf
    v_add_f32_dpp v41, v33, v33 quad_perm:[2,3,0,1] row_mask:0xf bank_mask:0xf
    v_add_f32_dpp v42, v34, v34 quad_perm:[2,3,0,1] row_mask:0xf bank_mask:0xf
    v_add_f32_dpp v43, v35, v35 quad_perm:[2,3,0,1] row_mask:0xf bank_mask:0xf
    v_cndmask_b32 v32, v40, v42, s[66:67]
    v_cndmask_b32 v33, v41, v43, s[66:67]
    s_nop 0
    v_add_f32_dpp v40, v32, v32 quad_perm:[1,0,3,2] row_mask:0xf bank_mask:0xf
    v_add_f32_dpp v41, v33, v33 quad_perm:[1,0,3,2] row_mask:0xf bank_mask:0xf
    v_cndmask_b32 v24, v40, v41, s[68:69]
    v_dot2_f32_bf16 v32, v128, v20, 0
    v_dot2_f32_bf16 v32, v129, v21, v32
    v_dot2_f32_bf16 v32, v130, v22, v32
    v_dot2_f32_bf16 v32, v131, v23, v32
    v_dot2_f32_bf16 v33, v132, v20, 0
    v_dot2_f32_bf16 v33, v133, v21, v33
    v_dot2_f32_bf16 v33, v134, v22, v33
    v_dot2_f32_bf16 v33, v135, v23, v33
    s_waitcnt vmcnt(5)
    buffer_load_dwordx4 v[96:99], v2, s[40:43], s63 offen nt
    s_add_u32 s63, s63, 4096
    v_dot2_f32_bf16 v34, v136, v20, 0
    v_dot2_f32_bf16 v34, v137, v21, v34
    v_dot2_f32_bf16 v34, v138, v22, v34
    v_dot2_f32_bf16 v34, v139, v23, v34
    v_dot2_f32_bf16 v35, v140, v20, 0
    v_dot2_f32_bf16 v35, v141, v21, v35
    v_dot2_f32_bf16 v35, v142, v22, v35
    v_dot2_f32_bf16 v35, v143, v23, v35
    v_dot2_f32_bf16 v36, v144, v20, 0
    v_dot2_f32_bf16 v36, v145, v21, v36
    v_dot2_f32_bf16 v36, v146, v22, v36
    v_dot2_f32_bf16 v36, v147, v23, v36
    s_waitcnt vmcnt(5)
    buffer_load_dwordx4 v[100:103], v2, s[40:43], s63 offen nt
    s_add_u32 s63, s63, 4096
    v_dot2_f32_bf16 v37, v148, v20, 0
    v_dot2_f32_bf16 v37, v149, v21, v37
    v_dot2_f32_bf16 v37, v150, v22, v37
    v_dot2_f32_bf16 v37, v151, v23, v37
    v_dot2_f32_bf16 v38, v152, v20, 0
    v_dot2_f32_bf16 v38, v153, v21, v38
    v_dot2_f32_bf16 v38, v154, v22, v38
    v_dot2_f32_bf16 v38, v155, v23, v38
    v_dot2_f32_bf16 v39, v156, v20, 0
    v_dot2_f32_bf16 v39, v157, v21, v39
    v_dot2_f32_bf16 v39, v158, v22, v39
    v_dot2_f32_bf16 v39, v159, v23, v39
    s_waitcnt vmcnt(5)
    buffer_load_dwordx4 v[104:107], v2, s[40:43], s63 offen nt
    s_add_u32 s63, s63, 4096
    v_dot2_f32_bf16 v40, v160, v20, 0
    v_dot2_f32_bf16 v40, v161, v21, v40
    v_dot2_f32_bf16 v40, v162, v22, v40
    v_dot2_f32_bf16 v40, v163, v23, v40
    v_dot2_f32_bf16 v41, v164, v20, 0
    v_dot2_f32_bf16 v41, v165, v21, v41
    v_dot2_f32_bf16 v41, v166, v22, v41
    v_dot2_f32_bf16 v41, v167, v23, v41
    v_dot2_f32_bf16 v42, v168, v20, 0
    v_dot2_f32_bf16 v42, v169, v21, v42
    v_dot2_f32_bf16 v42, v170, v22, v42
    v_dot2_f32_bf16 v42, v171, v23, v42
    s_waitcnt vmcnt(5)
    buffer_load_dwordx4 v[108:111], v2, s[40:43], s63 offen nt
    s_add_u32 s63, s63, 4096
    v_dot2_f32_bf16 v43, v172, v20, 0
    v_dot2_f32_bf16 v43, v173, v21, v43
    v_dot2_f32_bf16 v43, v174, v22, v43
    v_dot2_f32_bf16 v43, v175, v23, v43
    v_dot2_f32_bf16 v44, v176, v20, 0
    v_dot2_f32_bf16 v44, v177, v21, v44
    v_dot2_f32_bf16 v44, v178, v22, v44
    v_dot2_f32_bf16 v44, v179, v23, v44
    v_dot2_f32_bf16 v45, v180, v20, 0
    v_dot2_f32_bf16 v45, v181, v21, v45
    v_dot2_f32_bf16 v45, v182, v22, v45
    v_dot2_f32_bf16 v45, v183, v23, v45
    s_waitcnt vmcnt(5)
    buffer_load_dwordx4 v[112:115], v2, s[40:43], s63 offen nt
    s_add_u32 s63, s63, 4096
    v_dot2_f32_bf16 v46, v184, v20, 0
    v_dot2_f32_bf16 v46, v185, v21, v46
    v_dot2_f32_bf16 v46, v186, v22, v46
    v_dot2_f32_bf16 v46, v187, v23, v46
    v_dot2_f32_bf16 v47, v188, v20, 0
    v_dot2_f32_bf16 v47, v189, v21, v47
    v_dot2_f32_bf16 v47, v190, v22, v47
    v_dot2_f32_bf16 v47, v191, v23, v47
    v_add_f32_dpp v32, v32, v32 row_ror:8 row_mask:0xf bank_mask:0x3
    v_add_f32_dpp v33, v33, v33 row_ror:8 row_mask:0xf bank_mask:0x3
    v_add_f32_dpp v34, v34, v34 row_ror:8 row_mask:0xf bank_mask:0x3
    v_add_f32_dpp v35, v35, v35 row_ror:8 row_mask:0xf bank_mask:0x3
    v_add_f32_dpp v36, v36, v36 row_ror:8 row_mask:0xf bank_mask:0x3
    v_add_f32_dpp v37, v37, v37 row_ror:8 row_mask:0xf bank_mask:0x3
    v_add_f32_dpp v38, v38, v38 row_ror:8 row_mask:0xf bank_mask:0x3
    v_add_f32_dpp v39, v39, v39 row_ror:8 row_mask:0xf bank_mask:0x3
    v_add_f32_dpp v32, v40, v40 row_ror:8 row_mask:0xf bank_mask:0xc
    v_add_f32_dpp v33, v41, v41 row_ror:8 row_mask:0xf bank_mask:0xc
    v_add_f32_dpp v34, v42, v42 row_ror:8 row_mask:0xf bank_mask:0xc
    v_add_f32_dpp v35, v43, v43 row_ror:8 row_mask:0xf bank_mask:0xc
    v_add_f32_dpp v36, v44, v44 row_ror:8 row_mask:0xf bank_mask:0xc
    v_add_f32_dpp v37, v45, v45 row_ror:8 row_mask:0xf bank_mask:0xc
    v_add_f32_dpp v38, v46, v46 row_ror:8 row_mask:0xf bank_mask:0xc
    v_add_f32_dpp v39, v47, v47 row_ror:8 row_mask:0xf bank_mask:0xc
    v_add_f32_dpp v32, v32, v32 row_half_mirror row_mask:0xf bank_mask:0x5
    v_add_f32_dpp v33, v33, v33 row_half_mirror row_mask:0xf bank_mask:0x5
    v_add_f32_dpp v34, v34, v34 row_half_mirror row_mask:0xf bank_mask:0x5
    v_add_f32_dpp v35, v35, v35 row_half_mirror row_mask:0xf bank_mask:0x5
    v_add_f32_dpp v32, v36, v36 row_half_mirror row_mask:0xf bank_mask:0xa
    v_add_f32_dpp v33, v37, v37 row_half_mirror row_mask:0xf bank_mask:0xa
    v_add_f32_dpp v34, v38, v38 row_half_mirror row_mask:0xf bank_mask:0xa
    v_add_f32_dpp v35, v39, v39 row_half_mirror row_mask:0xf bank_mask:0xa
    v_add_f32_dpp v40, v32, v32 quad_perm:[2,3,0,1] row_mask:0xf bank_mask:0xf
    v_add_f32_dpp v41, v33, v33 quad_perm:[2,3,0,1] row_mask:0xf bank_mask:0xf
    v_add_f32_dpp v42, v34, v34 quad_perm:[2,3,0,1] row_mask:0xf bank_mask:0xf
    v_add_f32_dpp v43, v35, v35 quad_perm:[2,3,0,1] row_mask:0xf bank_mask:0xf
    v_cndmask_b32 v32, v40, v42, s[66:67]
    v_cndmask_b32 v33, v41, v43, s[66:67]
    s_nop 0
    v_add_f32_dpp v40, v32, v32 quad_perm:[1,0,3,2] row_mask:0xf bank_mask:0xf
    v_add_f32_dpp v41, v33, v33 quad_perm:[1,0,3,2] row_mask:0xf bank_mask:0xf
    v_cndmask_b32 v25, v40, v41, s[68:69]
    v_cvt_pk_bf16_f32 v24, v24, v24
    v_cvt_pk_bf16_f32 v25, v25, v25
    v_and_b32 v24, 0xffff0000, v24
    v_and_b32 v25, 0xffff0000, v25
    v_mul_f32 v24, s70, v24
    v_mul_f32 v25, s70, v25
    v_cvt_pk_bf16_f32 v24, v24, v24
    v_cvt_pk_bf16_f32 v25, v25, v25
    v_and_b32 v24, 0xffff0000, v24
    v_and_b32 v25, 0xffff0000, v25
    s_waitcnt vmcnt(5)
    buffer_load_dwordx4 v[116:119], v2, s[40:43], s63 offen nt
    s_add_u32 s63, s63, 4096
    v_max_f32 v28, v24, v25
    s_nop 1
    v_max_f32_dpp v28, v28, v28 row_ror:8 row_mask:0xf bank_mask:0xf
    s_nop 1
    v_max_f32_dpp v28, v28, v28 row_ror:4 row_mask:0xf bank_mask:0xf
    s_nop 1
    v_max_f32_dpp v28, v28, v28 row_ror:2 row_mask:0xf bank_mask:0xf
    s_nop 1
    v_max_f32_dpp v28, v28, v28 row_ror:1 row_mask:0xf bank_mask:0xf
    v_mov_b32 v29, v28
    s_nop 1
    v_permlane16_swap_b32 v29, v28
    v_max_f32 v28, v28, v29
    v_mov_b32 v29, v28
    s_nop 1
    v_permlane32_swap_b32 v29, v28
    v_max_f32 v28, v28, v29
    s_waitcnt vmcnt(5)
    buffer_load_dwordx4 v[120:123], v2, s[40:43], s63 offen nt
    s_add_u32 s63, s63, 4096
    v_sub_f32 v24, v24, v28
    v_sub_f32 v25, v25, v28
    v_mul_f32 v24, s71, v24
    v_mul_f32 v25, s71, v25
    v_exp_f32 v24, v24
    v_exp_f32 v25, v25
    s_nop 0
    v_add_f32 v30, v24, v25
    v_cvt_pk_bf16_f32 v24, v24, v24
    v_cvt_pk_bf16_f32 v25, v25, v25
    v_mov_b32 v48, 0
    v_mov_b32 v49, 0
    v_mov_b32 v50, 0
    v_mov_b32 v51, 0
    v_and_b32_dpp v32, v24, v16 row_newbcast:0 row_mask:0xf bank_mask:0xf
    v_and_b32_dpp v33, v24, v17 row_newbcast:0 row_mask:0xf bank_mask:0xf
    v_and_b32_dpp v34, v24, v18 row_newbcast:0 row_mask:0xf bank_mask:0xf
    v_and_b32_dpp v35, v24, v19 row_newbcast:0 row_mask:0xf bank_mask:0xf
    v_and_b32_dpp v36, v24, v16 row_newbcast:1 row_mask:0xf bank_mask:0xf
    v_and_b32_dpp v37, v24, v17 row_newbcast:1 row_mask:0xf bank_mask:0xf
    v_and_b32_dpp v38, v24, v18 row_newbcast:1 row_mask:0xf bank_mask:0xf
    v_and_b32_dpp v39, v24, v19 row_newbcast:1 row_mask:0xf bank_mask:0xf
    v_mfma_f32_16x16x32_bf16 v[48:51], v[32:35], v[192:195], v[48:51]
    s_waitcnt vmcnt(5)
    buffer_load_dwordx4 v[124:127], v2, s[40:43], s63 offen nt
    s_add_u32 s63, s63, 4096
    s_waitcnt lgkmcnt(0)
    s_cmp_lt_u32 s76, 256
    s_cbranch_scc0 Ls_nodyn
    s_lshr_b32 s60, s76, 5
    s_lshl_b32 s60, s60, 18
    s_and_b32 s58, s76, 31
    s_lshl_b32 s58, s58, 12
    s_add_u32 s60, s60, s58
    s_add_u32 s60, s60, 131072
    buffer_load_dwordx4 v[128:131], v3, s[44:47], s60 offen offset:0 nt
    buffer_load_dwordx4 v[132:135], v3, s[44:47], s60 offen offset:1024 nt
    buffer_load_dwordx4 v[136:139], v3, s[44:47], s60 offen offset:2048 nt
    buffer_load_dwordx4 v[140:143], v3, s[44:47], s60 offen offset:3072 nt
    buffer_load_dwordx4 v[160:163], v3, s[48:51], s60 offen offset:0 nt
    buffer_load_dwordx4 v[164:167], v3, s[48:51], s60 offen offset:1024 nt
    buffer_load_dwordx4 v[168:171], v3, s[48:51], s60 offen offset:2048 nt
    buffer_load_dwordx4 v[172:175], v3, s[48:51], s60 offen offset:3072 nt
    s_mov_b32 s77, 1
    s_atomic_add s77, s[56:57], 0 glc
    v_and_b32_dpp v32, v24, v16 row_newbcast:2 row_mask:0xf bank_mask:0xf
    v_and_b32_dpp v33, v24, v17 row_newbcast:2 row_mask:0xf bank_mask:0xf
    v_and_b32_dpp v34, v24, v18 row_newbcast:2 row_mask:0xf bank_mask:0xf
    v_and_b32_dpp v35, v24, v19 row_newbcast:2 row_mask:0xf bank_mask:0xf
    v_mfma_f32_16x16x32_bf16 v[48:51], v[36:39], v[196:199], v[48:51]
    v_and_b32_dpp v36, v24, v16 row_newbcast:3 row_mask:0xf bank_mask:0xf
    v_and_b32_dpp v37, v24, v17 row_newbcast:3 row_mask:0xf bank_mask:0xf
    v_and_b32_dpp v38, v24, v18 row_newbcast:3 row_mask:0xf bank_mask:0xf
    v_and_b32_dpp v39, v24, v19 row_newbcast:3 row_mask:0xf bank_mask:0xf
    v_mfma_f32_16x16x32_bf16 v[48:51], v[32:35], v[200:203], v[48:51]
    v_and_b32_dpp v32, v24, v16 row_newbcast:4 row_mask:0xf bank_mask:0xf
    v_and_b32_dpp v33, v24, v17 row_newbcast:4 row_mask:0xf bank_mask:0xf
    v_and_b32_dpp v34, v24, v18 row_newbcast:4 row_mask:0xf bank_mask:0xf
    v_and_b32_dpp v35, v24, v19 row_newbcast:4 row_mask:0xf bank_mask:0xf
    v_mfma_f32_16x16x32_bf16 v[48:51], v[36:39], v[204:207], v[48:51]
    v_and_b32_dpp v36, v24, v16 row_newbcast:5 row_mask:0xf bank_mask:0xf
    v_and_b32_dpp v37, v24, v17 row_newbcast:5 row_mask:0xf bank_mask:0xf
    v_and_b32_dpp v38, v24, v18 row_newbcast:5 row_mask:0xf bank_mask:0xf
    v_and_b32_dpp v39, v24, v19 row_newbcast:5 row_mask:0xf bank_mask:0xf
    v_mfma_f32_16x16x32_bf16 v[48:51], v[32:35], v[208:211], v[48:51]
    v_and_b32_dpp v32, v24, v16 row_newbcast:6 row_mask:0xf bank_mask:0xf
    v_and_b32_dpp v33, v24, v17 row_newbcast:6 row_mask:0xf bank_mask:0xf
    v_and_b32_dpp v34, v24, v18 row_newbcast:6 row_mask:0xf bank_mask:0xf
    v_and_b32_dpp v35, v24, v19 row_newbcast:6 row_mask:0xf bank_mask:0xf
    v_mfma_f32_16x16x32_bf16 v[48:51], v[36:39], v[212:215], v[48:51]
    v_and_b32_dpp v36, v24, v16 row_newbcast:7 row_mask:0xf bank_mask:0xf
    v_and_b32_dpp v37, v24, v17 row_newbcast:7 row_mask:0xf bank_mask:0xf
    v_and_b32_dpp v38, v24, v18 row_newbcast:7 row_mask:0xf bank_mask:0xf
    v_and_b32_dpp v39, v24, v19 row_newbcast:7 row_mask:0xf bank_mask:0xf
    v_mfma_f32_16x16x32_bf16 v[48:51], v[32:35], v[216:219], v[48:51]
    v_and_b32_dpp v32, v24, v16 row_newbcast:8 row_mask:0xf bank_mask:0xf
    v_and_b32_dpp v33, v24, v17 row_newbcast:8 row_mask:0xf bank_mask:0xf
    v_and_b32_dpp v34, v24, v18 row_newbcast:8 row_mask:0xf bank_mask:0xf
    v_and_b32_dpp v35, v24, v19 row_newbcast:8 row_mask:0xf bank_mask:0xf
    v_mfma_f32_16x16x32_bf16 v[48:51], v[36:39], v[220:223], v[48:51]
    v_and_b32_dpp v36, v24, v16 row_newbcast:9 row_mask:0xf bank_mask:0xf
    v_and_b32_dpp v37, v24, v17 row_newbcast:9 row_mask:0xf bank_mask:0xf
    v_and_b32_dpp v38, v24, v18 row_newbcast:9 row_mask:0xf bank_mask:0xf
    v_and_b32_dpp v39, v24, v19 row_newbcast:9 row_mask:0xf bank_mask:0xf
    v_mfma_f32_16x16x32_bf16 v[48:51], v[32:35], v[224:227], v[48:51]
    v_and_b32_dpp v32, v24, v16 row_newbcast:10 row_mask:0xf bank_mask:0xf
    v_and_b32_dpp v33, v24, v17 row_newbcast:10 row_mask:0xf bank_mask:0xf
    v_and_b32_dpp v34, v24, v18 row_newbcast:10 row_mask:0xf bank_mask:0xf
    v_and_b32_dpp v35, v24, v19 row_newbcast:10 row_mask:0xf bank_mask:0xf
    v_mfma_f32_16x16x32_bf16 v[48:51], v[36:39], v[228:231], v[48:51]
    v_and_b32_dpp v36, v24, v16 row_newbcast:11 row_mask:0xf bank_mask:0xf
    v_and_b32_dpp v37, v24, v17 row_newbcast:11 row_mask:0xf bank_mask:0xf
    v_and_b32_dpp v38, v24, v18 row_newbcast:11 row_mask:0xf bank_mask:0xf
    v_and_b32_dpp v39, v24, v19 row_newbcast:11 row_mask:0xf bank_mask:0xf
    v_mfma_f32_16x16x32_bf16 v[48:51], v[32:35], v[232:235], v[48:51]
    v_and_b32_dpp v32, v24, v16 row_newbcast:12 row_mask:0xf bank_mask:0xf
    v_and_b32_dpp v33, v24, v17 row_newbcast:12 row_mask:0xf bank_mask:0xf
    v_and_b32_dpp v34, v24, v18 row_newbcast:12 row_mask:0xf bank_mask:0xf
    v_and_b32_dpp v35, v24, v19 row_newbcast:12 row_mask:0xf bank_mask:0xf
    v_mfma_f32_16x16x32_bf16 v[48:51], v[36:39], v[236:239], v[48:51]
    v_and_b32_dpp v36, v24, v16 row_newbcast:13 row_mask:0xf bank_mask:0xf
    v_and_b32_dpp v37, v24, v17 row_newbcast:13 row_mask:0xf bank_mask:0xf
    v_and_b32_dpp v38, v24, v18 row_newbcast:13 row_mask:0xf bank_mask:0xf
    v_and_b32_dpp v39, v24, v19 row_newbcast:13 row_mask:0xf bank_mask:0xf
    v_mfma_f32_16x16x32_bf16 v[48:51], v[32:35], v[240:243], v[48:51]
    v_and_b32_dpp v32, v24, v16 row_newbcast:14 row_mask:0xf bank_mask:0xf
    v_and_b32_dpp v33, v24, v17 row_newbcast:14 row_mask:0xf bank_mask:0xf
    v_and_b32_dpp v34, v24, v18 row_newbcast:14 row_mask:0xf bank_mask:0xf
    v_and_b32_dpp v35, v24, v19 row_newbcast:14 row_mask:0xf bank_mask:0xf
    v_mfma_f32_16x16x32_bf16 v[48:51], v[36:39], v[244:247], v[48:51]
    v_and_b32_dpp v36, v24, v16 row_newbcast:15 row_mask:0xf bank_mask:0xf
    v_and_b32_dpp v37, v24, v17 row_newbcast:15 row_mask:0xf bank_mask:0xf
    v_and_b32_dpp v38, v24, v18 row_newbcast:15 row_mask:0xf bank_mask:0xf
    v_and_b32_dpp v39, v24, v19 row_newbcast:15 row_mask:0xf bank_mask:0xf
    v_mfma_f32_16x16x32_bf16 v[48:51], v[32:35], v[248:251], v[48:51]
    v_and_b32_dpp v32, v25, v16 row_newbcast:0 row_mask:0xf bank_mask:0xf
    v_and_b32_dpp v33, v25, v17 row_newbcast:0 row_mask:0xf bank_mask:0xf
    v_and_b32_dpp v34, v25, v18 row_newbcast:0 row_mask:0xf bank_mask:0xf
    v_and_b32_dpp v35, v25, v19 row_newbcast:0 row_mask:0xf bank_mask:0xf
    v_mfma_f32_16x16x32_bf16 v[48:51], v[36:39], v[252:255], v[48:51]
    v_and_b32_dpp v36, v25, v16 row_newbcast:1 row_mask:0xf bank_mask:0xf
    v_and_b32_dpp v37, v25, v17 row_newbcast:1 row_mask:0xf bank_mask:0xf
    v_and_b32_dpp v38, v25, v18 row_newbcast:1 row_mask:0xf bank_mask:0xf
    v_and_b32_dpp v39, v25, v19 row_newbcast:1 row_mask:0xf bank_mask:0xf
    v_mfma_f32_16x16x32_bf16 v[48:51], v[32:35], v[64:67], v[48:51]
    v_and_b32_dpp v32, v25, v16 row_newbcast:2 row_mask:0xf bank_mask:0xf
    v_and_b32_dpp v33, v25, v17 row_newbcast:2 row_mask:0xf bank_mask:0xf
    v_and_b32_dpp v34, v25, v18 row_newbcast:2 row_mask:0xf bank_mask:0xf
    v_and_b32_dpp v35, v25, v19 row_newbcast:2 row_mask:0xf bank_mask:0xf
    v_mfma_f32_16x16x32_bf16 v[48:51], v[36:39], v[68:71], v[48:51]
    v_and_b32_dpp v36, v25, v16 row_newbcast:3 row_mask:0xf bank_mask:0xf
    v_and_b32_dpp v37, v25, v17 row_newbcast:3 row_mask:0xf bank_mask:0xf
    v_and_b32_dpp v38, v25, v18 row_newbcast:3 row_mask:0xf bank_mask:0xf
    v_and_b32_dpp v39, v25, v19 row_newbcast:3 row_mask:0xf bank_mask:0xf
    v_mfma_f32_16x16x32_bf16 v[48:51], v[32:35], v[72:75], v[48:51]
    v_and_b32_dpp v32, v25, v16 row_newbcast:4 row_mask:0xf bank_mask:0xf
    v_and_b32_dpp v33, v25, v17 row_newbcast:4 row_mask:0xf bank_mask:0xf
    v_and_b32_dpp v34, v25, v18 row_newbcast:4 row_mask:0xf bank_mask:0xf
    v_and_b32_dpp v35, v25, v19 row_newbcast:4 row_mask:0xf bank_mask:0xf
    v_mfma_f32_16x16x32_bf16 v[48:51], v[36:39], v[76:79], v[48:51]
    v_and_b32_dpp v36, v25, v16 row_newbcast:5 row_mask:0xf bank_mask:0xf
    v_and_b32_dpp v37, v25, v17 row_newbcast:5 row_mask:0xf bank_mask:0xf
    v_and_b32_dpp v38, v25, v18 row_newbcast:5 row_mask:0xf bank_mask:0xf
    v_and_b32_dpp v39, v25, v19 row_newbcast:5 row_mask:0xf bank_mask:0xf
    v_mfma_f32_16x16x32_bf16 v[48:51], v[32:35], v[80:83], v[48:51]
    v_and_b32_dpp v32, v25, v16 row_newbcast:6 row_mask:0xf bank_mask:0xf
    v_and_b32_dpp v33, v25, v17 row_newbcast:6 row_mask:0xf bank_mask:0xf
    v_and_b32_dpp v34, v25, v18 row_newbcast:6 row_mask:0xf bank_mask:0xf
    v_and_b32_dpp v35, v25, v19 row_newbcast:6 row_mask:0xf bank_mask:0xf
    v_mfma_f32_16x16x32_bf16 v[48:51], v[36:39], v[84:87], v[48:51]
    v_and_b32_dpp v36, v25, v16 row_newbcast:7 row_mask:0xf bank_mask:0xf
    v_and_b32_dpp v37, v25, v17 row_newbcast:7 row_mask:0xf bank_mask:0xf
    v_and_b32_dpp v38, v25, v18 row_newbcast:7 row_mask:0xf bank_mask:0xf
    v_and_b32_dpp v39, v25, v19 row_newbcast:7 row_mask:0xf bank_mask:0xf
    v_mfma_f32_16x16x32_bf16 v[48:51], v[32:35], v[88:91], v[48:51]
    v_and_b32_dpp v32, v25, v16 row_newbcast:8 row_mask:0xf bank_mask:0xf
    v_and_b32_dpp v33, v25, v17 row_newbcast:8 row_mask:0xf bank_mask:0xf
    v_and_b32_dpp v34, v25, v18 row_newbcast:8 row_mask:0xf bank_mask:0xf
    v_and_b32_dpp v35, v25, v19 row_newbcast:8 row_mask:0xf bank_mask:0xf
    v_mfma_f32_16x16x32_bf16 v[48:51], v[36:39], v[92:95], v[48:51]
    v_and_b32_dpp v36, v25, v16 row_newbcast:9 row_mask:0xf bank_mask:0xf
    v_and_b32_dpp v37, v25, v17 row_newbcast:9 row_mask:0xf bank_mask:0xf
    v_and_b32_dpp v38, v25, v18 row_newbcast:9 row_mask:0xf bank_mask:0xf
    v_and_b32_dpp v39, v25, v19 row_newbcast:9 row_mask:0xf bank_mask:0xf
    v_mfma_f32_16x16x32_bf16 v[48:51], v[32:35], v[96:99], v[48:51]
    v_and_b32_dpp v32, v25, v16 row_newbcast:10 row_mask:0xf bank_mask:0xf
    v_and_b32_dpp v33, v25, v17 row_newbcast:10 row_mask:0xf bank_mask:0xf
    v_and_b32_dpp v34, v25, v18 row_newbcast:10 row_mask:0xf bank_mask:0xf
    v_and_b32_dpp v35, v25, v19 row_newbcast:10 row_mask:0xf bank_mask:0xf
    v_mfma_f32_16x16x32_bf16 v[48:51], v[36:39], v[100:103], v[48:51]
    v_and_b32_dpp v36, v25, v16 row_newbcast:11 row_mask:0xf bank_mask:0xf
    v_and_b32_dpp v37, v25, v17 row_newbcast:11 row_mask:0xf bank_mask:0xf
    v_and_b32_dpp v38, v25, v18 row_newbcast:11 row_mask:0xf bank_mask:0xf
    v_and_b32_dpp v39, v25, v19 row_newbcast:11 row_mask:0xf bank_mask:0xf
    s_waitcnt vmcnt(13)
    v_mfma_f32_16x16x32_bf16 v[48:51], v[32:35], v[104:107], v[48:51]
    v_and_b32_dpp v32, v25, v16 row_newbcast:12 row_mask:0xf bank_mask:0xf
    v_and_b32_dpp v33, v25, v17 row_newbcast:12 row_mask:0xf bank_mask:0xf
    v_and_b32_dpp v34, v25, v18 row_newbcast:12 row_mask:0xf bank_mask:0xf
    v_and_b32_dpp v35, v25, v19 row_newbcast:12 row_mask:0xf bank_mask:0xf
    s_waitcnt vmcnt(12)
    v_mfma_f32_16x16x32_bf16 v[48:51], v[36:39], v[108:111], v[48:51]
    v_and_b32_dpp v36, v25, v16 row_newbcast:13 row_mask:0xf bank_mask:0xf
    v_and_b32_dpp v37, v25, v17 row_newbcast:13 row_mask:0xf bank_mask:0xf
    v_and_b32_dpp v38, v25, v18 row_newbcast:13 row_mask:0xf bank_mask:0xf
    v_and_b32_dpp v39, v25, v19 row_newbcast:13 row_mask:0xf bank_mask:0xf
    s_waitcnt vmcnt(11)
    v_mfma_f32_16x16x32_bf16 v[48:51], v[32:35], v[112:115], v[48:51]
    v_and_b32_dpp v32, v25, v16 row_newbcast:14 row_mask:0xf bank_mask:0xf
    v_and_b32_dpp v33, v25, v17 row_newbcast:14 row_mask:0xf bank_mask:0xf
    v_and_b32_dpp v34, v25, v18 row_newbcast:14 row_mask:0xf bank_mask:0xf
    v_and_b32_dpp v35, v25, v19 row_newbcast:14 row_mask:0xf bank_mask:0xf
    s_waitcnt vmcnt(10)
    v_mfma_f32_16x16x32_bf16 v[48:51], v[36:39], v[116:119], v[48:51]
    v_and_b32_dpp v36, v25, v16 row_newbcast:15 row_mask:0xf bank_mask:0xf
    v_and_b32_dpp v37, v25, v17 row_newbcast:15 row_mask:0xf bank_mask:0xf
    v_and_b32_dpp v38, v25, v18 row_newbcast:15 row_mask:0xf bank_mask:0xf
    v_and_b32_dpp v39, v25, v19 row_newbcast:15 row_mask:0xf bank_mask:0xf
    s_waitcnt vmcnt(9)
    v_mfma_f32_16x16x32_bf16 v[48:51], v[32:35], v[120:123], v[48:51]
    s_waitcnt vmcnt(8)
    v_mfma_f32_16x16x32_bf16 v[48:51], v[36:39], v[124:127], v[48:51]
    v_mov_b32 v31, 0.25
Ld_top0:
    s_waitcnt vmcnt(4) lgkmcnt(0)
    s_mov_b32 s62, 0
    s_cmp_lt_u32 s77, 256
    s_cbranch_scc0 Ld_nomore0
    s_mov_b32 s62, 1
    s_lshr_b32 s61, s77, 5
    s_lshl_b32 s61, s61, 18
    s_and_b32 s58, s77, 31
    s_lshl_b32 s58, s58, 12
    s_add_u32 s61, s61, s58
    s_add_u32 s61, s61, 131072
    buffer_load_dwordx4 v[144:147], v3, s[44:47], s61 offen offset:0 nt
    buffer_load_dwordx4 v[148:151], v3, s[44:47], s61 offen offset:1024 nt
    buffer_load_dwordx4 v[152:155], v3, s[44:47], s61 offen offset:2048 nt
    buffer_load_dwordx4 v[156:159], v3, s[44:47], s61 offen offset:3072 nt
    buffer_load_dwordx4 v[176:179], v3, s[48:51], s61 offen offset:0 nt
    buffer_load_dwordx4 v[180:183], v3, s[48:51], s61 offen offset:1024 nt
    buffer_load_dwordx4 v[184:187], v3, s[48:51], s61 offen offset:2048 nt
    buffer_load_dwordx4 v[188:191], v3, s[48:51], s61 offen offset:3072 nt
    s_mov_b32 s76, 1
    s_atomic_add s76, s[56:57], 0 glc
Ld_nomore0:
    v_dot2_f32_bf16 v32, v128, v20, 0
    v_dot2_f32_bf16 v33, v132, v20, 0
    v_dot2_f32_bf16 v34, v136, v20, 0
    v_dot2_f32_bf16 v35, v140, v20, 0
    v_dot2_f32_bf16 v32, v129, v21, v32
    v_dot2_f32_bf16 v33, v133, v21, v33
    v_dot2_f32_bf16 v34, v137, v21, v34
    v_dot2_f32_bf16 v35, v141, v21, v35
    v_dot2_f32_bf16 v32, v130, v22, v32
    v_dot2_f32_bf16 v33, v134, v22, v33
    v_dot2_f32_bf16 v34, v138, v22, v34
    v_dot2_f32_bf16 v35, v142, v22, v35
    v_dot2_f32_bf16 v32, v131, v23, v32
    v_dot2_f32_bf16 v33, v135, v23, v33
    v_dot2_f32_bf16 v34, v139, v23, v34
    v_dot2_f32_bf16 v35, v143, v23, v35
    v_add_f32_dpp v32, v32, v32 row_ror:8 row_mask:0xf bank_mask:0x3
    v_add_f32_dpp v33, v33, v33 row_ror:8 row_mask:0xf bank_mask:0x3
    s_nop 0
    v_add_f32_dpp v32, v34, v34 row_ror:8 row_mask:0xf bank_mask:0xc
    v_add_f32_dpp v33, v35, v35 row_ror:8 row_mask:0xf bank_mask:0xc
    s_nop 0
    v_add_f32_dpp v32, v32, v32 row_half_mirror row_mask:0xf bank_mask:0x5
    s_nop 1
    v_add_f32_dpp v32, v33, v33 row_half_mirror row_mask:0xf bank_mask:0xa
    s_nop 1
    v_add_f32_dpp v32, v32, v32 quad_perm:[2,3,0,1] row_mask:0xf bank_mask:0xf
    s_nop 1
    v_add_f32_dpp v32, v32, v32 quad_perm:[1,0,3,2] row_mask:0xf bank_mask:0xf
    v_cvt_pk_bf16_f32 v32, v32, v32
    v_and_b32 v32, 0xffff0000, v32
    v_mul_f32 v32, s70, v32
    v_cvt_pk_bf16_f32 v32, v32, v32
    v_and_b32 v32, 0xffff0000, v32
    v_cmp_gt_f32 vcc, v32, v28
    s_cbranch_vccz Ld_nors0
    v_mov_b32 v33, v32
    s_nop 1
    v_max_f32_dpp v33, v33, v33 row_ror:8 row_mask:0xf bank_mask:0xf
    s_nop 1
    v_max_f32_dpp v33, v33, v33 row_ror:4 row_mask:0xf bank_mask:0xf
    s_nop 1
    v_max_f32_dpp v33, v33, v33 row_ror:2 row_mask:0xf bank_mask:0xf
    s_nop 1
    v_max_f32_dpp v33, v33, v33 row_ror:1 row_mask:0xf bank_mask:0xf
    v_mov_b32 v34, v33
    s_nop 1
    v_permlane16_swap_b32 v34, v33
    v_max_f32 v33, v33, v34
    v_mov_b32 v34, v33
    s_nop 1
    v_permlane32_swap_b32 v34, v33
    v_max_f32 v33, v33, v34
    v_max_f32 v33, v33, v28
    v_sub_f32 v34, v28, v33
    v_mul_f32 v34, s71, v34
    v_exp_f32 v34, v34
    v_mov_b32 v28, v33
    v_mul_f32 v30, v30, v34
    v_mul_f32 v48, v48, v34
    v_mul_f32 v49, v49, v34
    v_mul_f32 v50, v50, v34
    v_mul_f32 v51, v51, v34
Ld_nors0:
    v_sub_f32 v32, v32, v28
    v_mul_f32 v32, s71, v32
    v_exp_f32 v32, v32
    s_nop 0
    v_fma_f32 v30, v32, v31, v30
    v_cvt_pk_bf16_f32 v24, v32, v32
    s_nop 1
    v_and_b32_dpp v36, v24, v16 row_newbcast:0 row_mask:0xf bank_mask:0xf
    v_and_b32_dpp v37, v24, v17 row_newbcast:0 row_mask:0xf bank_mask:0xf
    v_and_b32_dpp v38, v24, v18 row_newbcast:0 row_mask:0xf bank_mask:0xf
    v_and_b32_dpp v39, v24, v19 row_newbcast:0 row_mask:0xf bank_mask:0xf
    s_cmp_eq_u32 s62, 0
    s_cbranch_scc1 Ld_w0_0
    s_waitcnt vmcnt(8)
    s_branch Ld_w1_0
Ld_w0_0:
    s_waitcnt vmcnt(0)
Ld_w1_0:
    v_mfma_f32_16x16x32_bf16 v[48:51], v[36:39], v[160:163], v[48:51]
    v_and_b32_dpp v40, v24, v16 row_newbcast:4 row_mask:0xf bank_mask:0xf
    v_and_b32_dpp v41, v24, v17 row_newbcast:4 row_mask:0xf bank_mask:0xf
    v_and_b32_dpp v42, v24, v18 row_newbcast:4 row_mask:0xf bank_mask:0xf
    v_and_b32_dpp v43, v24, v19 row_newbcast:4 row_mask:0xf bank_mask:0xf
    s_nop 1
    v_mfma_f32_16x16x32_bf16 v[48:51], v[40:43], v[164:167], v[48:51]
    v_and_b32_dpp v36, v24, v16 row_newbcast:8 row_mask:0xf bank_mask:0xf
    v_and_b32_dpp v37, v24, v17 row_newbcast:8 row_mask:0xf bank_mask:0xf
    v_and_b32_dpp v38, v24, v18 row_newbcast:8 row_mask:0xf bank_mask:0xf
    v_and_b32_dpp v39, v24, v19 row_newbcast:8 row_mask:0xf bank_mask:0xf
    s_nop 1
    v_mfma_f32_16x16x32_bf16 v[48:51], v[36:39], v[168:171], v[48:51]
    v_and_b32_dpp v40, v24, v16 row_newbcast:12 row_mask:0xf bank_mask:0xf
    v_and_b32_dpp v41, v24, v17 row_newbcast:12 row_mask:0xf bank_mask:0xf
    v_and_b32_dpp v42, v24, v18 row_newbcast:12 row_mask:0xf bank_mask:0xf
    v_and_b32_dpp v43, v24, v19 row_newbcast:12 row_mask:0xf bank_mask:0xf
    s_nop 1
    v_mfma_f32_16x16x32_bf16 v[48:51], v[40:43], v[172:175], v[48:51]
    s_cmp_eq_u32 s62, 0
    s_cbranch_scc1 Ls_vdone
Ld_top1:
    s_waitcnt vmcnt(4) lgkmcnt(0)
    s_mov_b32 s62, 0
    s_cmp_lt_u32 s76, 256
    s_cbranch_scc0 Ld_nomore1
    s_mov_b32 s62, 1
    s_lshr_b32 s60, s76, 5
    s_lshl_b32 s60, s60, 18
    s_and_b32 s58, s76, 31
    s_lshl_b32 s58, s58, 12
    s_add_u32 s60, s60, s58
    s_add_u32 s60, s60, 131072
    buffer_load_dwordx4 v[128:131], v3, s[44:47], s60 offen offset:0 nt
    buffer_load_dwordx4 v[132:135], v3, s[44:47], s60 offen offset:1024 nt
    buffer_load_dwordx4 v[136:139], v3, s[44:47], s60 offen offset:2048 nt
    buffer_load_dwordx4 v[140:143], v3, s[44:47], s60 offen offset:3072 nt
    buffer_load_dwordx4 v[160:163], v3, s[48:51], s60 offen offset:0 nt
    buffer_load_dwordx4 v[164:167], v3, s[48:51], s60 offen offset:1024 nt
    buffer_load_dwordx4 v[168:171], v3, s[48:51], s60 offen offset:2048 nt
    buffer_load_dwordx4 v[172:175], v3, s[48:51], s60 offen offset:3072 nt
    s_mov_b32 s77, 1
    s_atomic_add s77, s[56:57], 0 glc
Ld_nomore1:
    v_dot2_f32_bf16 v32, v144, v20, 0
    v_dot2_f32_bf16 v33, v148, v20, 0
    v_dot2_f32_bf16 v34, v152, v20, 0
    v_dot2_f32_bf16 v35, v156, v20, 0
    v_dot2_f32_bf16 v32, v145, v21, v32
    v_dot2_f32_bf16 v33, v149, v21, v33
    v_dot2_f32_bf16 v34, v153, v21, v34
    v_dot2_f32_bf16 v35, v157, v21, v35
    v_dot2_f32_bf16 v32, v146, v22, v32
    v_dot2_f32_bf16 v33, v150, v22, v33
    v_dot2_f32_bf16 v34, v154, v22, v34
    v_dot2_f32_bf16 v35, v158, v22, v35
    v_dot2_f32_bf16 v32, v147, v23, v32
    v_dot2_f32_bf16 v33, v151, v23, v33
    v_dot2_f32_bf16 v34, v155, v23, v34
    v_dot2_f32_bf16 v35, v159, v23, v35
    v_add_f32_dpp v32, v32, v32 row_ror:8 row_mask:0xf bank_mask:0x3
    v_add_f32_dpp v33, v33, v33 row_ror:8 row_mask:0xf bank_mask:0x3
    s_nop 0
    v_add_f32_dpp v32, v34, v34 row_ror:8 row_mask:0xf bank_mask:0xc
    v_add_f32_dpp v33, v35, v35 row_ror:8 row_mask:0xf bank_mask:0xc
    s_nop 0
    v_add_f32_dpp v32, v32, v32 row_half_mirror row_mask:0xf bank_mask:0x5
    s_nop 1
    v_add_f32_dpp v32, v33, v33 row_half_mirror row_mask:0xf bank_mask:0xa
    s_nop 1
    v_add_f32_dpp v32, v32, v32 quad_perm:[2,3,0,1] row_mask:0xf bank_mask:0xf
    s_nop 1
    v_add_f32_dpp v32, v32, v32 quad_perm:[1,0,3,2] row_mask:0xf bank_mask:0xf
    v_cvt_pk_bf16_f32 v32, v32, v32
    v_and_b32 v32, 0xffff0000, v32
    v_mul_f32 v32, s70, v32
    v_cvt_pk_bf16_f32 v32, v32, v32
    v_and_b32 v32, 0xffff0000, v32
    v_cmp_gt_f32 vcc, v32, v28
    s_cbranch_vccz Ld_nors1
    v_mov_b32 v33, v32
    s_nop 1
    v_max_f32_dpp v33, v33, v33 row_ror:8 row_mask:0xf bank_mask:0xf
    s_nop 1
    v_max_f32_dpp v33, v33, v33 row_ror:4 row_mask:0xf bank_mask:0xf
    s_nop 1
    v_max_f32_dpp v33, v33, v33 row_ror:2 row_mask:0xf bank_mask:0xf
    s_nop 1
    v_max_f32_dpp v33, v33, v33 row_ror:1 row_mask:0xf bank_mask:0xf
    v_mov_b32 v34, v33
    s_nop 1
    v_permlane16_swap_b32 v34, v33
    v_max_f32 v33, v33, v34
    v_mov_b32 v34, v33
    s_nop 1
    v_permlane32_swap_b32 v34, v33
    v_max_f32 v33, v33, v34
    v_max_f32 v33, v33, v28
    v_sub_f32 v34, v28, v33
    v_mul_f32 v34, s71, v34
    v_exp_f32 v34, v34
    v_mov_b32 v28, v33
    v_mul_f32 v30, v30, v34
    v_mul_f32 v48, v48, v34
    v_mul_f32 v49, v49, v34
    v_mul_f32 v50, v50, v34
    v_mul_f32 v51, v51, v34
Ld_nors1:
    v_sub_f32 v32, v32, v28
    v_mul_f32 v32, s71, v32
    v_exp_f32 v32, v32
    s_nop 0
    v_fma_f32 v30, v32, v31, v30
    v_cvt_pk_bf16_f32 v24, v32, v32
    s_nop 1
    v_and_b32_dpp v36, v24, v16 row_newbcast:0 row_mask:0xf bank_mask:0xf
    v_and_b32_dpp v37, v24, v17 row_newbcast:0 row_mask:0xf bank_mask:0xf
    v_and_b32_dpp v38, v24, v18 row_newbcast:0 row_mask:0xf bank_mask:0xf
    v_and_b32_dpp v39, v24, v19 row_newbcast:0 row_mask:0xf bank_mask:0xf
    s_cmp_eq_u32 s62, 0
    s_cbranch_scc1 Ld_w0_1
    s_waitcnt vmcnt(8)
    s_branch Ld_w1_1
Ld_w0_1:
    s_waitcnt vmcnt(0)
Ld_w1_1:
    v_mfma_f32_16x16x32_bf16 v[48:51], v[36:39], v[176:179], v[48:51]
    v_and_b32_dpp v40, v24, v16 row_newbcast:4 row_mask:0xf bank_mask:0xf
    v_and_b32_dpp v41, v24, v17 row_newbcast:4 row_mask:0xf bank_mask:0xf
    v_and_b32_dpp v42, v24, v18 row_newbcast:4 row_mask:0xf bank_mask:0xf
    v_and_b32_dpp v43, v24, v19 row_newbcast:4 row_mask:0xf bank_mask:0xf
    s_nop 1
    v_mfma_f32_16x16x32_bf16 v[48:51], v[40:43], v[180:183], v[48:51]
    v_and_b32_dpp v36, v24, v16 row_newbcast:8 row_mask:0xf bank_mask:0xf
    v_and_b32_dpp v37, v24, v17 row_newbcast:8 row_mask:0xf bank_mask:0xf
    v_and_b32_dpp v38, v24, v18 row_newbcast:8 row_mask:0xf bank_mask:0xf
    v_and_b32_dpp v39, v24, v19 row_newbcast:8 row_mask:0xf bank_mask:0xf
    s_nop 1
    v_mfma_f32_16x16x32_bf16 v[48:51], v[36:39], v[184:187], v[48:51]
    v_and_b32_dpp v40, v24, v16 row_newbcast:12 row_mask:0xf bank_mask:0xf
    v_and_b32_dpp v41, v24, v17 row_newbcast:12 row_mask:0xf bank_mask:0xf
    v_and_b32_dpp v42, v24, v18 row_newbcast:12 row_mask:0xf bank_mask:0xf
    v_and_b32_dpp v43, v24, v19 row_newbcast:12 row_mask:0xf bank_mask:0xf
    s_nop 1
    v_mfma_f32_16x16x32_bf16 v[48:51], v[40:43], v[188:191], v[48:51]
    s_cmp_eq_u32 s62, 0
    s_cbranch_scc1 Ls_vdone
    s_branch Ld_top0
Ls_nodyn:
    v_and_b32_dpp v32, v24, v16 row_newbcast:2 row_mask:0xf bank_mask:0xf
    v_and_b32_dpp v33, v24, v17 row_newbcast:2 row_mask:0xf bank_mask:0xf
    v_and_b32_dpp v34, v24, v18 row_newbcast:2 row_mask:0xf bank_mask:0xf
    v_and_b32_dpp v35, v24, v19 row_newbcast:2 row_mask:0xf bank_mask:0xf
    v_mfma_f32_16x16x32_bf16 v[48:51], v[36:39], v[196:199], v[48:51]
    v_and_b32_dpp v36, v24, v16 row_newbcast:3 row_mask:0xf bank_mask:0xf
    v_and_b32_dpp v37, v24, v17 row_newbcast:3 row_mask:0xf bank_mask:0xf
    v_and_b32_dpp v38, v24, v18 row_newbcast:3 row_mask:0xf bank_mask:0xf
    v_and_b32_dpp v39, v24, v19 row_newbcast:3 row_mask:0xf bank_mask:0xf
    v_mfma_f32_16x16x32_bf16 v[48:51], v[32:35], v[200:203], v[48:51]
    v_and_b32_dpp v32, v24, v16 row_newbcast:4 row_mask:0xf bank_mask:0xf
    v_and_b32_dpp v33, v24, v17 row_newbcast:4 row_mask:0xf bank_mask:0xf
    v_and_b32_dpp v34, v24, v18 row_newbcast:4 row_mask:0xf bank_mask:0xf
    v_and_b32_dpp v35, v24, v19 row_newbcast:4 row_mask:0xf bank_mask:0xf
    v_mfma_f32_16x16x32_bf16 v[48:51], v[36:39], v[204:207], v[48:51]
    v_and_b32_dpp v36, v24, v16 row_newbcast:5 row_mask:0xf bank_mask:0xf
    v_and_b32_dpp v37, v24, v17 row_newbcast:5 row_mask:0xf bank_mask:0xf
    v_and_b32_dpp v38, v24, v18 row_newbcast:5 row_mask:0xf bank_mask:0xf
    v_and_b32_dpp v39, v24, v19 row_newbcast:5 row_mask:0xf bank_mask:0xf
    v_mfma_f32_16x16x32_bf16 v[48:51], v[32:35], v[208:211], v[48:51]
    v_and_b32_dpp v32, v24, v16 row_newbcast:6 row_mask:0xf bank_mask:0xf
    v_and_b32_dpp v33, v24, v17 row_newbcast:6 row_mask:0xf bank_mask:0xf
    v_and_b32_dpp v34, v24, v18 row_newbcast:6 row_mask:0xf bank_mask:0xf
    v_and_b32_dpp v35, v24, v19 row_newbcast:6 row_mask:0xf bank_mask:0xf
    v_mfma_f32_16x16x32_bf16 v[48:51], v[36:39], v[212:215], v[48:51]
    v_and_b32_dpp v36, v24, v16 row_newbcast:7 row_mask:0xf bank_mask:0xf
    v_and_b32_dpp v37, v24, v17 row_newbcast:7 row_mask:0xf bank_mask:0xf
    v_and_b32_dpp v38, v24, v18 row_newbcast:7 row_mask:0xf bank_mask:0xf
    v_and_b32_dpp v39, v24, v19 row_newbcast:7 row_mask:0xf bank_mask:0xf
    v_mfma_f32_16x16x32_bf16 v[48:51], v[32:35], v[216:219], v[48:51]
    v_and_b32_dpp v32, v24, v16 row_newbcast:8 row_mask:0xf bank_mask:0xf
    v_and_b32_dpp v33, v24, v17 row_newbcast:8 row_mask:0xf bank_mask:0xf
    v_and_b32_dpp v34, v24, v18 row_newbcast:8 row_mask:0xf bank_mask:0xf
    v_and_b32_dpp v35, v24, v19 row_newbcast:8 row_mask:0xf bank_mask:0xf
    v_mfma_f32_16x16x32_bf16 v[48:51], v[36:39], v[220:223], v[48:51]
    v_and_b32_dpp v36, v24, v16 row_newbcast:9 row_mask:0xf bank_mask:0xf
    v_and_b32_dpp v37, v24, v17 row_newbcast:9 row_mask:0xf bank_mask:0xf
    v_and_b32_dpp v38, v24, v18 row_newbcast:9 row_mask:0xf bank_mask:0xf
    v_and_b32_dpp v39, v24, v19 row_newbcast:9 row_mask:0xf bank_mask:0xf
    v_mfma_f32_16x16x32_bf16 v[48:51], v[32:35], v[224:227], v[48:51]
    v_and_b32_dpp v32, v24, v16 row_newbcast:10 row_mask:0xf bank_mask:0xf
    v_and_b32_dpp v33, v24, v17 row_newbcast:10 row_mask:0xf bank_mask:0xf
    v_and_b32_dpp v34, v24, v18 row_newbcast:10 row_mask:0xf bank_mask:0xf
    v_and_b32_dpp v35, v24, v19 row_newbcast:10 row_mask:0xf bank_mask:0xf
    v_mfma_f32_16x16x32_bf16 v[48:51], v[36:39], v[228:231], v[48:51]
    v_and_b32_dpp v36, v24, v16 row_newbcast:11 row_mask:0xf bank_mask:0xf
    v_and_b32_dpp v37, v24, v17 row_newbcast:11 row_mask:0xf bank_mask:0xf
    v_and_b32_dpp v38, v24, v18 row_newbcast:11 row_mask:0xf bank_mask:0xf
    v_and_b32_dpp v39, v24, v19 row_newbcast:11 row_mask:0xf bank_mask:0xf
    v_mfma_f32_16x16x32_bf16 v[48:51], v[32:35], v[232:235], v[48:51]
    v_and_b32_dpp v32, v24, v16 row_newbcast:12 row_mask:0xf bank_mask:0xf
    v_and_b32_dpp v33, v24, v17 row_newbcast:12 row_mask:0xf bank_mask:0xf
    v_and_b32_dpp v34, v24, v18 row_newbcast:12 row_mask:0xf bank_mask:0xf
    v_and_b32_dpp v35, v24, v19 row_newbcast:12 row_mask:0xf bank_mask:0xf
    v_mfma_f32_16x16x32_bf16 v[48:51], v[36:39], v[236:239], v[48:51]
    v_and_b32_dpp v36, v24, v16 row_newbcast:13 row_mask:0xf bank_mask:0xf
    v_and_b32_dpp v37, v24, v17 row_newbcast:13 row_mask:0xf bank_mask:0xf
    v_and_b32_dpp v38, v24, v18 row_newbcast:13 row_mask:0xf bank_mask:0xf
    v_and_b32_dpp v39, v24, v19 row_newbcast:13 row_mask:0xf bank_mask:0xf
    v_mfma_f32_16x16x32_bf16 v[48:51], v[32:35], v[240:243], v[48:51]
    v_and_b32_dpp v32, v24, v16 row_newbcast:14 row_mask:0xf bank_mask:0xf
    v_and_b32_dpp v33, v24, v17 row_newbcast:14 row_mask:0xf bank_mask:0xf
    v_and_b32_dpp v34, v24, v18 row_newbcast:14 row_mask:0xf bank_mask:0xf
    v_and_b32_dpp v35, v24, v19 row_newbcast:14 row_mask:0xf bank_mask:0xf
    v_mfma_f32_16x16x32_bf16 v[48:51], v[36:39], v[244:247], v[48:51]
    v_and_b32_dpp v36, v24, v16 row_newbcast:15 row_mask:0xf bank_mask:0xf
    v_and_b32_dpp v37, v24, v17 row_newbcast:15 row_mask:0xf bank_mask:0xf
    v_and_b32_dpp v38, v24, v18 row_newbcast:15 row_mask:0xf bank_mask:0xf
    v_and_b32_dpp v39, v24, v19 row_newbcast:15 row_mask:0xf bank_mask:0xf
    v_mfma_f32_16x16x32_bf16 v[48:51], v[32:35], v[248:251], v[48:51]
    v_and_b32_dpp v32, v25, v16 row_newbcast:0 row_mask:0xf bank_mask:0xf
    v_and_b32_dpp v33, v25, v17 row_newbcast:0 row_mask:0xf bank_mask:0xf
    v_and_b32_dpp v34, v25, v18 row_newbcast:0 row_mask:0xf bank_mask:0xf
    v_and_b32_dpp v35, v25, v19 row_newbcast:0 row_mask:0xf bank_mask:0xf
    v_mfma_f32_16x16x32_bf16 v[48:51], v[36:39], v[252:255], v[48:51]
    v_and_b32_dpp v36, v25, v16 row_newbcast:1 row_mask:0xf bank_mask:0xf
    v_and_b32_dpp v37, v25, v17 row_newbcast:1 row_mask:0xf bank_mask:0xf
    v_and_b32_dpp v38, v25, v18 row_newbcast:1 row_mask:0xf bank_mask:0xf
    v_and_b32_dpp v39, v25, v19 row_newbcast:1 row_mask:0xf bank_mask:0xf
    v_mfma_f32_16x16x32_bf16 v[48:51], v[32:35], v[64:67], v[48:51]
    v_and_b32_dpp v32, v25, v16 row_newbcast:2 row_mask:0xf bank_mask:0xf
    v_and_b32_dpp v33, v25, v17 row_newbcast:2 row_mask:0xf bank_mask:0xf
    v_and_b32_dpp v34, v25, v18 row_newbcast:2 row_mask:0xf bank_mask:0xf
    v_and_b32_dpp v35, v25, v19 row_newbcast:2 row_mask:0xf bank_mask:0xf
    v_mfma_f32_16x16x32_bf16 v[48:51], v[36:39], v[68:71], v[48:51]
    v_and_b32_dpp v36, v25, v16 row_newbcast:3 row_mask:0xf bank_mask:0xf
    v_and_b32_dpp v37, v25, v17 row_newbcast:3 row_mask:0xf bank_mask:0xf
    v_and_b32_dpp v38, v25, v18 row_newbcast:3 row_mask:0xf bank_mask:0xf
    v_and_b32_dpp v39, v25, v19 row_newbcast:3 row_mask:0xf bank_mask:0xf
    v_mfma_f32_16x16x32_bf16 v[48:51], v[32:35], v[72:75], v[48:51]
    v_and_b32_dpp v32, v25, v16 row_newbcast:4 row_mask:0xf bank_mask:0xf
    v_and_b32_dpp v33, v25, v17 row_newbcast:4 row_mask:0xf bank_mask:0xf
    v_and_b32_dpp v34, v25, v18 row_newbcast:4 row_mask:0xf bank_mask:0xf
    v_and_b32_dpp v35, v25, v19 row_newbcast:4 row_mask:0xf bank_mask:0xf
    v_mfma_f32_16x16x32_bf16 v[48:51], v[36:39], v[76:79], v[48:51]
    v_and_b32_dpp v36, v25, v16 row_newbcast:5 row_mask:0xf bank_mask:0xf
    v_and_b32_dpp v37, v25, v17 row_newbcast:5 row_mask:0xf bank_mask:0xf
    v_and_b32_dpp v38, v25, v18 row_newbcast:5 row_mask:0xf bank_mask:0xf
    v_and_b32_dpp v39, v25, v19 row_newbcast:5 row_mask:0xf bank_mask:0xf
    v_mfma_f32_16x16x32_bf16 v[48:51], v[32:35], v[80:83], v[48:51]
    v_and_b32_dpp v32, v25, v16 row_newbcast:6 row_mask:0xf bank_mask:0xf
    v_and_b32_dpp v33, v25, v17 row_newbcast:6 row_mask:0xf bank_mask:0xf
    v_and_b32_dpp v34, v25, v18 row_newbcast:6 row_mask:0xf bank_mask:0xf
    v_and_b32_dpp v35, v25, v19 row_newbcast:6 row_mask:0xf bank_mask:0xf
    v_mfma_f32_16x16x32_bf16 v[48:51], v[36:39], v[84:87], v[48:51]
    v_and_b32_dpp v36, v25, v16 row_newbcast:7 row_mask:0xf bank_mask:0xf
    v_and_b32_dpp v37, v25, v17 row_newbcast:7 row_mask:0xf bank_mask:0xf
    v_and_b32_dpp v38, v25, v18 row_newbcast:7 row_mask:0xf bank_mask:0xf
    v_and_b32_dpp v39, v25, v19 row_newbcast:7 row_mask:0xf bank_mask:0xf
    v_mfma_f32_16x16x32_bf16 v[48:51], v[32:35], v[88:91], v[48:51]
    v_and_b32_dpp v32, v25, v16 row_newbcast:8 row_mask:0xf bank_mask:0xf
    v_and_b32_dpp v33, v25, v17 row_newbcast:8 row_mask:0xf bank_mask:0xf
    v_and_b32_dpp v34, v25, v18 row_newbcast:8 row_mask:0xf bank_mask:0xf
    v_and_b32_dpp v35, v25, v19 row_newbcast:8 row_mask:0xf bank_mask:0xf
    v_mfma_f32_16x16x32_bf16 v[48:51], v[36:39], v[92:95], v[48:51]
    v_and_b32_dpp v36, v25, v16 row_newbcast:9 row_mask:0xf bank_mask:0xf
    v_and_b32_dpp v37, v25, v17 row_newbcast:9 row_mask:0xf bank_mask:0xf
    v_and_b32_dpp v38, v25, v18 row_newbcast:9 row_mask:0xf bank_mask:0xf
    v_and_b32_dpp v39, v25, v19 row_newbcast:9 row_mask:0xf bank_mask:0xf
    v_mfma_f32_16x16x32_bf16 v[48:51], v[32:35], v[96:99], v[48:51]
    v_and_b32_dpp v32, v25, v16 row_newbcast:10 row_mask:0xf bank_mask:0xf
    v_and_b32_dpp v33, v25, v17 row_newbcast:10 row_mask:0xf bank_mask:0xf
    v_and_b32_dpp v34, v25, v18 row_newbcast:10 row_mask:0xf bank_mask:0xf
    v_and_b32_dpp v35, v25, v19 row_newbcast:10 row_mask:0xf bank_mask:0xf
    v_mfma_f32_16x16x32_bf16 v[48:51], v[36:39], v[100:103], v[48:51]
    v_and_b32_dpp v36, v25, v16 row_newbcast:11 row_mask:0xf bank_mask:0xf
    v_and_b32_dpp v37, v25, v17 row_newbcast:11 row_mask:0xf bank_mask:0xf
    v_and_b32_dpp v38, v25, v18 row_newbcast:11 row_mask:0xf bank_mask:0xf
    v_and_b32_dpp v39, v25, v19 row_newbcast:11 row_mask:0xf bank_mask:0xf
    s_waitcnt vmcnt(5)
    v_mfma_f32_16x16x32_bf16 v[48:51], v[32:35], v[104:107], v[48:51]
    v_and_b32_dpp v32, v25, v16 row_newbcast:12 row_mask:0xf bank_mask:0xf
    v_and_b32_dpp v33, v25, v17 row_newbcast:12 row_mask:0xf bank_mask:0xf
    v_and_b32_dpp v34, v25, v18 row_newbcast:12 row_mask:0xf bank_mask:0xf
    v_and_b32_dpp v35, v25, v19 row_newbcast:12 row_mask:0xf bank_mask:0xf
    s_waitcnt vmcnt(4)
    v_mfma_f32_16x16x32_bf16 v[48:51], v[36:39], v[108:111], v[48:51]
    v_and_b32_dpp v36, v25, v16 row_newbcast:13 row_mask:0xf bank_mask:0xf
    v_and_b32_dpp v37, v25, v17 row_newbcast:13 row_mask:0xf bank_mask:0xf
    v_and_b32_dpp v38, v25, v18 row_newbcast:13 row_mask:0xf bank_mask:0xf
    v_and_b32_dpp v39, v25, v19 row_newbcast:13 row_mask:0xf bank_mask:0xf
    s_waitcnt vmcnt(3)
    v_mfma_f32_16x16x32_bf16 v[48:51], v[32:35], v[112:115], v[48:51]
    v_and_b32_dpp v32, v25, v16 row_newbcast:14 row_mask:0xf bank_mask:0xf
    v_and_b32_dpp v33, v25, v17 row_newbcast:14 row_mask:0xf bank_mask:0xf
    v_and_b32_dpp v34, v25, v18 row_newbcast:14 row_mask:0xf bank_mask:0xf
    v_and_b32_dpp v35, v25, v19 row_newbcast:14 row_mask:0xf bank_mask:0xf
    s_waitcnt vmcnt(2)
    v_mfma_f32_16x16x32_bf16 v[48:51], v[36:39], v[116:119], v[48:51]
    v_and_b32_dpp v36, v25, v16 row_newbcast:15 row_mask:0xf bank_mask:0xf
    v_and_b32_dpp v37, v25, v17 row_newbcast:15 row_mask:0xf bank_mask:0xf
    v_and_b32_dpp v38, v25, v18 row_newbcast:15 row_mask:0xf bank_mask:0xf
    v_and_b32_dpp v39, v25, v19 row_newbcast:15 row_mask:0xf bank_mask:0xf
    s_waitcnt vmcnt(1)
    v_mfma_f32_16x16x32_bf16 v[48:51], v[32:35], v[120:123], v[48:51]
    s_waitcnt vmcnt(0)
    v_mfma_f32_16x16x32_bf16 v[48:51], v[36:39], v[124:127], v[48:51]
Ls_vdone:
    v_add_f32_dpp v30, v30, v30 row_ror:8 row_mask:0xf bank_mask:0xf
    s_nop 1
    v_add_f32_dpp v30, v30, v30 row_ror:4 row_mask:0xf bank_mask:0xf
    s_nop 1
    v_add_f32_dpp v30, v30, v30 row_ror:2 row_mask:0xf bank_mask:0xf
    s_nop 1
    v_add_f32_dpp v30, v30, v30 row_ror:1 row_mask:0xf bank_mask:0xf
    v_mov_b32 v31, v30
    s_nop 1
    v_permlane16_swap_b32 v31, v30
    v_add_f32 v30, v30, v31
    v_mov_b32 v31, v30
    s_nop 1
    v_permlane32_swap_b32 v31, v30
    v_add_f32 v30, v30, v31
    v_and_b32 v12, 15, v0
    v_lshlrev_b32 v12, 5, v12
    v_lshrrev_b32 v13, 4, v0
    v_lshl_add_u32 v12, v13, 4, v12
    s_lshl_b32 s56, s3, 9
    s_add_u32 s56, s56, 110592
    v_add_u32 v12, s56, v12
    s_lshl_b32 s56, s3, 3
    s_add_u32 s56, s56, 112640
    v_mov_b32 v13, s56
    v_mov_b32 v29, v30
    s_mov_b32 exec_lo, -1
    s_mov_b32 exec_hi, 0
    ds_write_b128 v12, v[48:51]
    s_mov_b64 exec, 1
    ds_write_b64 v13, v[28:29]
    s_mov_b64 exec, -1
    s_waitcnt lgkmcnt(0)
    s_branch Ltail
Lnonstream:
    s_cmp_eq_u32 s3, 4
    s_cbranch_scc1 Lchain
    s_cmp_eq_u32 s3, 5
    s_cbranch_scc0 Lidle0
    s_branch Ltlb_done
    s_lshl_b32 s58, s2, 18
    v_mov_b32 v2, s58
    global_load_dword v204, v2, s[12:13] nt
    s_mul_i32 s58, s4, 18
    s_add_u32 s58, s58, s100
    s_min_u32 s58, s58, 143
    s_mul_i32 s58, s58, 36864
    v_mov_b32 v2, s58
    global_load_dword v205, v2, s[24:25] nt
    v_mov_b32 v2, 0
    global_load_dword v206, v2, s[30:31]
Ltlb_done:
    s_getpc_b64 s[56:57]
Lpc:
    s_sub_u32 s56, s56, Lpc-adaLN_cond__mha_block_cached__glu_gated_glu__decode_kernel
    s_subb_u32 s57, s57, 0
    s_cmp_lt_u32 s5, 4
    s_cbranch_scc0 Lidle0
    s_mov_b32 s58, (Lcode_end-adaLN_cond__mha_block_cached__glu_gated_glu__decode_kernel)/4096
    s_mul_i32 s59, s58, s5
    s_lshl_b32 s59, s59, 10
    v_lshlrev_b32 v2, 4, v0
    v_add_u32 v2, s59, v2
Lpf:
    global_load_dwordx4 v[200:203], v2, s[56:57]
    v_add_u32 v2, 1024, v2
    s_sub_u32 s58, s58, 1
    s_cmp_lg_u32 s58, 0
    s_cbranch_scc1 Lpf
Lidle0:
    s_barrier
    s_waitcnt lgkmcnt(0)
    s_add_u32 s7, s7, 1
    s_and_b32 s6, s7, 0xfff
    s_cmp_ge_u32 s3, 6
    s_cbranch_scc0 Lidle1
    s_and_b32 s58, s3, 1
    v_bfe_u32 v8, v0, 1, 2
    v_bfe_u32 v9, v0, 4, 1
    v_xor_b32 v8, v8, v9
    s_lshl_b32 s57, s58, 1
    v_xor_b32 v8, s57, v8
    v_lshlrev_b32 v8, 5, v8
    v_and_b32 v7, 1, v0
    v_lshl_add_u32 v8, v7, 4, v8
    v_lshrrev_b32 v9, 3, v0
    v_mov_b32 v50, 159744
    s_mov_b32 s59, 0
Lx_w:
    s_add_u32 s59, s59, 1
    s_cmp_lt_u32 s59, 0x400000
    s_cbranch_scc0 Lend
    s_sleep 4
    ds_read_b32 v51, v50
    s_waitcnt lgkmcnt(0)
    v_readfirstlane_b32 s56, v51
    s_nop 0
    s_cmp_lt_u32 s56, 4
    s_cbranch_scc1 Lx_w
    s_mov_b32 s59, 0
Lx_wx:
    s_add_u32 s59, s59, 1
    s_cmp_lt_u32 s59, 0x400000
    s_cbranch_scc0 Lend
    s_sleep 2
    ds_read_b32 v51, v50 offset:8
    s_waitcnt lgkmcnt(0)
    v_readfirstlane_b32 s56, v51
    s_nop 0
    s_cmp_eq_u32 s56, 0
    s_cbranch_scc1 Lx_wx
    s_cmp_eq_u32 s72, 1
    s_cbranch_scc0 Lx_nolazy
    s_mov_b32 s44, s28
    s_and_b32 s45, s29, 0xffff
    s_mov_b32 s46, 3981312
    s_mov_b32 s47, 0x20000
    s_movk_i32 s61, 6912
    v_mul_lo_u32 v4, v9, s61
    v_add_u32 v4, v4, v8
    s_mul_i32 s60, s74, 663552
    s_lshl_b32 s61, s73, 8
    s_add_u32 s60, s60, s61
    s_mul_i32 s61, s58, 55296
    s_add_u32 s60, s60, s61
    s_lshl_b32 s62, s58, 10
    s_add_u32 s62, s62, s75
    s_mov_b32 m0, s62
    s_waitcnt vmcnt(8)
    buffer_load_dwordx4 v4, s[44:47], s60 offen nt lds
    s_add_u32 s62, s62, 2048
    s_add_u32 s60, s60, 110592
    s_mov_b32 m0, s62
    s_waitcnt vmcnt(8)
    buffer_load_dwordx4 v4, s[44:47], s60 offen nt lds
    s_add_u32 s62, s62, 2048
    s_add_u32 s60, s60, 110592
    s_mov_b32 m0, s62
    s_waitcnt vmcnt(8)
    buffer_load_dwordx4 v4, s[44:47], s60 offen nt lds
    s_add_u32 s62, s62, 2048
    s_add_u32 s60, s60, 110592
    s_mov_b32 m0, s62
    s_waitcnt vmcnt(8)
    buffer_load_dwordx4 v4, s[44:47], s60 offen nt lds
    s_add_u32 s62, s62, 2048
    s_add_u32 s60, s60, 110592
    s_mov_b32 m0, s62
    s_waitcnt vmcnt(8)
    buffer_load_dwordx4 v4, s[44:47], s60 offen nt lds
    s_add_u32 s62, s62, 2048
    s_add_u32 s60, s60, 110592
    s_mov_b32 m0, s62
    s_waitcnt vmcnt(8)
    buffer_load_dwordx4 v4, s[44:47], s60 offen nt lds
    s_add_u32 s62, s62, 2048
    s_sub_u32 s60, s60, 552832
    s_mov_b32 m0, s62
    s_waitcnt vmcnt(8)
    buffer_load_dwordx4 v4, s[44:47], s60 offen nt lds
    s_add_u32 s62, s62, 2048
    s_add_u32 s60, s60, 110592
    s_mov_b32 m0, s62
    s_waitcnt vmcnt(8)
    buffer_load_dwordx4 v4, s[44:47], s60 offen nt lds
    s_add_u32 s62, s62, 2048
    s_add_u32 s60, s60, 110592
    s_mov_b32 m0, s62
    s_waitcnt vmcnt(8)
    buffer_load_dwordx4 v4, s[44:47], s60 offen nt lds
    s_add_u32 s62, s62, 2048
    s_add_u32 s60, s60, 110592
    s_mov_b32 m0, s62
    s_waitcnt vmcnt(8)
    buffer_load_dwordx4 v4, s[44:47], s60 offen nt lds
    s_add_u32 s62, s62, 2048
    s_add_u32 s60, s60, 110592
    s_mov_b32 m0, s62
    s_waitcnt vmcnt(8)
    buffer_load_dwordx4 v4, s[44:47], s60 offen nt lds
    s_add_u32 s62, s62, 2048
    s_add_u32 s60, s60, 110592
    s_mov_b32 m0, s62
    s_waitcnt vmcnt(8)
    buffer_load_dwordx4 v4, s[44:47], s60 offen nt lds
    s_add_u32 s62, s62, 2048
    s_waitcnt vmcnt(0)
    v_mov_b32 v51, 1
    s_mov_b64 exec, 1
    ds_add_u32 v50, v51 offset:4
    s_mov_b64 exec, -1
Lx_nolazy:
    s_cmp_lt_u32 s100, 18
    s_cbranch_scc0 Lx_notffn
    s_mov_b32 s59, 0
Lx_wg:
    s_add_u32 s59, s59, 1
    s_cmp_lt_u32 s59, 0x400000
    s_cbranch_scc0 Lend
    s_sleep 2
    ds_read_b32 v51, v50 offset:8
    s_waitcnt lgkmcnt(0)
    v_readfirstlane_b32 s56, v51
    s_nop 0
    s_cmp_eq_u32 s56, 0
    s_cbranch_scc1 Lx_wg
    s_mul_i32 s59, s4, 18
    s_add_u32 s59, s59, s100
    v_bfe_u32 v5, v0, 1, 1
    v_lshrrev_b32 v6, 5, v0
    v_xor_b32 v5, v5, v6
    v_lshlrev_b32 v5, 5, v5
    v_and_b32 v7, 1, v0
    v_lshl_add_u32 v5, v7, 4, v5
    v_lshrrev_b32 v6, 2, v0
    s_movk_i32 s61, 9216
    v_mul_lo_u32 v6, v6, s61
    v_add_u32 v6, v6, v5
    s_mov_b32 s44, s20
    s_and_b32 s45, s21, 0xffff
    s_mov_b32 s46, 5308416
    s_mov_b32 s47, 0x20000
    s_mov_b32 s48, s22
    s_and_b32 s49, s23, 0xffff
    s_mov_b32 s50, 5308416
    s_mov_b32 s51, 0x20000
    s_lshl_b32 s60, s59, 6
    s_mul_i32 s61, s58, 147456
    s_add_u32 s60, s60, s61
    s_lshl_b32 s62, s58, 10
    s_mov_b32 s64, 18
Lx_gu:
    s_mov_b32 m0, s62
    s_waitcnt vmcnt(8)
    buffer_load_dwordx4 v6, s[44:47], s60 offen nt lds
    s_add_u32 s65, s62, 36864
    s_mov_b32 m0, s65
    s_waitcnt vmcnt(8)
    buffer_load_dwordx4 v6, s[48:51], s60 offen nt lds
    s_add_u32 s62, s62, 2048
    s_add_u32 s60, s60, 294912
    s_sub_u32 s64, s64, 1
    s_cmp_lg_u32 s64, 0
    s_cbranch_scc1 Lx_gu
    s_branch Lqwait
Lx_notffn:
    s_cmp_lt_u32 s100, 27
    s_cbranch_scc0 Lidle1
    s_sub_u32 s59, s100, 18
    s_movk_i32 s61, 1152
    v_mul_lo_u32 v4, v9, s61
    v_add_u32 v4, v4, v8
    s_mov_b32 s44, s16
    s_and_b32 s45, s17, 0xffff
    s_mov_b32 s46, 4718592
    s_mov_b32 s47, 0x20000
    s_mul_i32 s60, s4, 589824
    s_mul_i32 s61, s58, 9216
    s_add_u32 s60, s60, s61
    s_lshl_b32 s61, s59, 7
    s_add_u32 s60, s60, s61
    s_lshl_b32 s62, s58, 10
    s_add_u32 s62, s62, 0
    s_mov_b32 s64, 32
Lx_wo:
    s_mov_b32 m0, s62
    s_waitcnt vmcnt(8)
    buffer_load_dwordx4 v4, s[44:47], s60 offen nt lds
    s_add_u32 s62, s62, 2048
    s_add_u32 s60, s60, 18432
    s_sub_u32 s64, s64, 1
    s_cmp_lg_u32 s64, 0
    s_cbranch_scc1 Lx_wo
Lidle1:
Lqwait:
    v_mov_b32 v50, 159744
    s_mov_b32 s59, 0
Lqw:
    s_add_u32 s59, s59, 1
    s_cmp_lt_u32 s59, 0x400000
    s_cbranch_scc0 Lend
    s_sleep 8
    ds_read_b32 v51, v50 offset:12
    s_waitcnt lgkmcnt(0)
    v_readfirstlane_b32 s56, v51
    s_nop 0
    s_cmp_eq_u32 s56, 0
    s_cbranch_scc1 Lqw
    s_branch Lpre
Lchain:
    s_setprio 3
    v_mov_b32 v2, 159744
    v_mov_b32 v4, 0
    v_mov_b32 v5, 0
    v_mov_b32 v6, 0
    v_mov_b32 v7, 0
    s_mov_b64 exec, 1
    ds_write_b128 v2, v[4:7]
    s_mov_b64 exec, -1
    s_mov_b32 s36, s8
    s_and_b32 s37, s9, 0xffff
    s_movk_i32 s38, 1152
    s_mov_b32 s39, 0x20000
    s_mov_b32 s40, s26
    s_and_b32 s41, s27, 0xffff
    s_movk_i32 s42, 1152
    s_mov_b32 s43, 0x20000
    s_cmp_eq_u32 s4, 0
    s_cbranch_scc0 Lc_noz
    s_lshl_b32 s56, s5, 8
    s_add_u32 s56, s56, 851968
    v_mov_b32 v7, s56
    s_mov_b64 exec, 1
    global_store_dword v7, v4, s[34:35] sc1
    s_mov_b64 exec, -1
Lc_noz:
    v_lshlrev_b32 v6, 3, v0
    s_mul_i32 s56, s54, 192
    buffer_load_dwordx2 v[16:17], v6, s[40:43], s56 offen
    v_lshlrev_b32 v3, 4, v0
    buffer_load_dwordx4 v[8:11], v3, s[36:39], 0 offen
    buffer_load_dwordx4 v[12:15], v3, s[36:39], 0 offen offset:1024
    s_mul_i32 s56, s4, 192
    buffer_load_dwordx2 v[24:25], v6, s[36:39], s56 offen
    v_mov_b32 v7, 4096
    global_load_dword v26, v7, s[34:35] sc1
    s_mul_i32 s56, s74, 192
    buffer_load_dwordx2 v[18:19], v6, s[40:43], s56 offen
    s_waitcnt lgkmcnt(0)
    s_barrier
    s_add_u32 s7, s7, 1
    s_and_b32 s6, s7, 0xfff
    s_cmp_ge_u32 s4, 6
    s_cbranch_scc0 Lc_qprod
    s_cmp_eq_u32 s52, 1
    s_cbranch_scc0 Lc_hopB
    s_waitcnt vmcnt(5)
    v_lshlrev_b32 v40, 16, v16
    v_and_b32 v41, 0xffff0000, v16
    v_lshlrev_b32 v42, 16, v17
    v_and_b32 v43, 0xffff0000, v17
    v_mul_f32 v44, 0xbfb8aa3b, v40
    v_mul_f32 v45, 0xbfb8aa3b, v41
    v_mul_f32 v46, 0xbfb8aa3b, v42
    v_mul_f32 v47, 0xbfb8aa3b, v43
    v_exp_f32 v44, v44
    v_exp_f32 v45, v45
    v_exp_f32 v46, v46
    v_exp_f32 v47, v47
    v_add_f32 v44, 1.0, v44
    v_add_f32 v45, 1.0, v45
    v_add_f32 v46, 1.0, v46
    v_add_f32 v47, 1.0, v47
    v_rcp_f32 v44, v44
    v_rcp_f32 v45, v45
    v_rcp_f32 v46, v46
    v_rcp_f32 v47, v47
    v_mul_f32 v40, v40, v44
    v_mul_f32 v41, v41, v45
    v_mul_f32 v42, v42, v46
    v_mul_f32 v43, v43, v47
    v_cvt_pk_bf16_f32 v40, v40, v41
    v_cvt_pk_bf16_f32 v41, v42, v43
    v_lshlrev_b32 v42, 3, v0
    v_add_u32 v42, 160000, v42
    s_mov_b32 exec_lo, 16777215
    s_mov_b32 exec_hi, 0
    ds_write_b64 v42, v[40:41]
    s_mov_b64 exec, -1
    v_lshrrev_b32 v47, 4, v0
    v_bfe_u32 v45, v0, 2, 2
    v_lshl_add_u32 v46, v47, 3, v45
    v_lshlrev_b32 v46, 7, v46
    v_and_b32 v47, 1, v47
    v_lshrrev_b32 v45, 1, v45
    v_lshl_or_b32 v45, v47, 1, v45
    v_lshlrev_b32 v45, 5, v45
    v_and_b32 v47, 3, v0
    v_lshl_add_u32 v46, v47, 3, v46
    v_add_u32 v46, 135168, v46
    v_xor_b32 v47, 0, v45
    v_add_u32 v60, v46, v47
    v_xor_b32 v47, 32, v45
    v_add_u32 v61, v46, v47
    v_xor_b32 v47, 64, v45
    v_add_u32 v62, v46, v47
    v_xor_b32 v47, 96, v45
    v_add_u32 v63, v46, v47
    v_lshrrev_b32 v44, 4, v0
    v_lshlrev_b32 v49, 4, v44
    v_add_u32 v49, 160000, v49
    v_mov_b32 v50, 159744
    s_mov_b32 s59, 0
Lwf_1:
    s_add_u32 s59, s59, 1
    s_cmp_lt_u32 s59, 0x1000000
    s_cbranch_scc0 Lend
    ds_read_b32 v51, v50 offset:0
    s_waitcnt lgkmcnt(0)
    v_readfirstlane_b32 s56, v51
    s_nop 0
    s_cmp_lt_u32 s56, 4
    s_cbranch_scc1 Lwf_1
    s_mul_i32 s56, s53, 6
    s_add_u32 s56, s56, s54
    s_lshl_b32 s56, s56, 7
    s_add_u32 s56, s56, 933888
    v_mov_b32 v30, s56
    s_or_b32 s57, s6, 0x5a5a5000
    v_mov_b32 v31, s57
    s_mov_b64 exec, 1
    global_store_dword v30, v31, s[34:35] sc1
    s_mov_b64 exec, -1
    ds_read_b128 v[64:67], v49 offset:0
    ds_read_b128 v[68:71], v49 offset:64
    ds_read_b128 v[72:75], v49 offset:128
    ds_read_b64_tr_b16 v[128:129], v60 offset:0
    ds_read_b64_tr_b16 v[130:131], v60 offset:512
    ds_read_b64_tr_b16 v[132:133], v61 offset:0
    ds_read_b64_tr_b16 v[134:135], v61 offset:512
    ds_read_b64_tr_b16 v[136:137], v62 offset:0
    ds_read_b64_tr_b16 v[138:139], v62 offset:512
    ds_read_b64_tr_b16 v[140:141], v63 offset:0
    ds_read_b64_tr_b16 v[142:143], v63 offset:512
    s_waitcnt lgkmcnt(0)
    ds_read_b64_tr_b16 v[144:145], v60 offset:4096
    ds_read_b64_tr_b16 v[146:147], v60 offset:4608
    ds_read_b64_tr_b16 v[148:149], v61 offset:4096
    ds_read_b64_tr_b16 v[150:151], v61 offset:4608
    ds_read_b64_tr_b16 v[152:153], v62 offset:4096
    ds_read_b64_tr_b16 v[154:155], v62 offset:4608
    ds_read_b64_tr_b16 v[156:157], v63 offset:4096
    ds_read_b64_tr_b16 v[158:159], v63 offset:4608
    v_mfma_f32_16x16x32_bf16 v[96:99], v[128:131], v[64:67], 0
    v_mfma_f32_16x16x32_bf16 v[100:103], v[132:135], v[64:67], 0
    v_mfma_f32_16x16x32_bf16 v[104:107], v[136:139], v[64:67], 0
    v_mfma_f32_16x16x32_bf16 v[108:111], v[140:143], v[64:67], 0
    s_waitcnt lgkmcnt(0)
    ds_read_b64_tr_b16 v[128:129], v60 offset:8192
    ds_read_b64_tr_b16 v[130:131], v60 offset:8704
    ds_read_b64_tr_b16 v[132:133], v61 offset:8192
    ds_read_b64_tr_b16 v[134:135], v61 offset:8704
    ds_read_b64_tr_b16 v[136:137], v62 offset:8192
    ds_read_b64_tr_b16 v[138:139], v62 offset:8704
    ds_read_b64_tr_b16 v[140:141], v63 offset:8192
    ds_read_b64_tr_b16 v[142:143], v63 offset:8704
    v_mfma_f32_16x16x32_bf16 v[96:99], v[144:147], v[68:71], v[96:99]
    v_mfma_f32_16x16x32_bf16 v[100:103], v[148:151], v[68:71], v[100:103]
    v_mfma_f32_16x16x32_bf16 v[104:107], v[152:155], v[68:71], v[104:107]
    v_mfma_f32_16x16x32_bf16 v[108:111], v[156:159], v[68:71], v[108:111]
    s_waitcnt lgkmcnt(0)
    ds_read_b64_tr_b16 v[144:145], v60 offset:12288
    ds_read_b64_tr_b16 v[146:147], v60 offset:12800
    ds_read_b64_tr_b16 v[148:149], v61 offset:12288
    ds_read_b64_tr_b16 v[150:151], v61 offset:12800
    ds_read_b64_tr_b16 v[152:153], v62 offset:12288
    ds_read_b64_tr_b16 v[154:155], v62 offset:12800
    ds_read_b64_tr_b16 v[156:157], v63 offset:12288
    ds_read_b64_tr_b16 v[158:159], v63 offset:12800
    v_mfma_f32_16x16x32_bf16 v[96:99], v[128:131], v[72:75], v[96:99]
    v_mfma_f32_16x16x32_bf16 v[100:103], v[132:135], v[72:75], v[100:103]
    v_mfma_f32_16x16x32_bf16 v[104:107], v[136:139], v[72:75], v[104:107]
    v_mfma_f32_16x16x32_bf16 v[108:111], v[140:143], v[72:75], v[108:111]
    s_waitcnt lgkmcnt(0)
    ds_read_b64_tr_b16 v[128:129], v60 offset:16384
    ds_read_b64_tr_b16 v[130:131], v60 offset:16896
    ds_read_b64_tr_b16 v[132:133], v61 offset:16384
    ds_read_b64_tr_b16 v[134:135], v61 offset:16896
    ds_read_b64_tr_b16 v[136:137], v62 offset:16384
    ds_read_b64_tr_b16 v[138:139], v62 offset:16896
    ds_read_b64_tr_b16 v[140:141], v63 offset:16384
    ds_read_b64_tr_b16 v[142:143], v63 offset:16896
    v_mfma_f32_16x16x32_bf16 v[112:115], v[144:147], v[64:67], 0
    v_mfma_f32_16x16x32_bf16 v[116:119], v[148:151], v[64:67], 0
    v_mfma_f32_16x16x32_bf16 v[120:123], v[152:155], v[64:67], 0
    v_mfma_f32_16x16x32_bf16 v[124:127], v[156:159], v[64:67], 0
    s_waitcnt lgkmcnt(0)
    ds_read_b64_tr_b16 v[144:145], v60 offset:20480
    ds_read_b64_tr_b16 v[146:147], v60 offset:20992
    ds_read_b64_tr_b16 v[148:149], v61 offset:20480
    ds_read_b64_tr_b16 v[150:151], v61 offset:20992
    ds_read_b64_tr_b16 v[152:153], v62 offset:20480
    ds_read_b64_tr_b16 v[154:155], v62 offset:20992
    ds_read_b64_tr_b16 v[156:157], v63 offset:20480
    ds_read_b64_tr_b16 v[158:159], v63 offset:20992
    v_mfma_f32_16x16x32_bf16 v[112:115], v[128:131], v[68:71], v[112:115]
    v_mfma_f32_16x16x32_bf16 v[116:119], v[132:135], v[68:71], v[116:119]
    v_mfma_f32_16x16x32_bf16 v[120:123], v[136:139], v[68:71], v[120:123]
    v_mfma_f32_16x16x32_bf16 v[124:127], v[140:143], v[68:71], v[124:127]
    s_waitcnt lgkmcnt(0)
    v_mfma_f32_16x16x32_bf16 v[112:115], v[144:147], v[72:75], v[112:115]
    v_mfma_f32_16x16x32_bf16 v[116:119], v[148:151], v[72:75], v[116:119]
    v_mfma_f32_16x16x32_bf16 v[120:123], v[152:155], v[72:75], v[120:123]
    v_mfma_f32_16x16x32_bf16 v[124:127], v[156:159], v[72:75], v[124:127]
    v_and_b32 v44, 15, v0
    v_cmp_eq_u32 vcc, 1, v44
    s_nop 1
    v_cndmask_b32 v96, v96, v100, vcc
    v_cndmask_b32 v97, v97, v101, vcc
    v_cndmask_b32 v98, v98, v102, vcc
    v_cndmask_b32 v99, v99, v103, vcc
    v_cmp_eq_u32 vcc, 2, v44
    s_nop 1
    v_cndmask_b32 v96, v96, v104, vcc
    v_cndmask_b32 v97, v97, v105, vcc
    v_cndmask_b32 v98, v98, v106, vcc
    v_cndmask_b32 v99, v99, v107, vcc
    v_cmp_eq_u32 vcc, 3, v44
    s_nop 1
    v_cndmask_b32 v96, v96, v108, vcc
    v_cndmask_b32 v97, v97, v109, vcc
    v_cndmask_b32 v98, v98, v110, vcc
    v_cndmask_b32 v99, v99, v111, vcc
    v_cmp_eq_u32 vcc, 4, v44
    s_nop 1
    v_cndmask_b32 v96, v96, v112, vcc
    v_cndmask_b32 v97, v97, v113, vcc
    v_cndmask_b32 v98, v98, v114, vcc
    v_cndmask_b32 v99, v99, v115, vcc
    v_cmp_eq_u32 vcc, 5, v44
    s_nop 1
    v_cndmask_b32 v96, v96, v116, vcc
    v_cndmask_b32 v97, v97, v117, vcc
    v_cndmask_b32 v98, v98, v118, vcc
    v_cndmask_b32 v99, v99, v119, vcc
    v_cmp_eq_u32 vcc, 6, v44
    s_nop 1
    v_cndmask_b32 v96, v96, v120, vcc
    v_cndmask_b32 v97, v97, v121, vcc
    v_cndmask_b32 v98, v98, v122, vcc
    v_cndmask_b32 v99, v99, v123, vcc
    v_cmp_eq_u32 vcc, 7, v44
    s_nop 1
    v_cndmask_b32 v96, v96, v124, vcc
    v_cndmask_b32 v97, v97, v125, vcc
    v_cndmask_b32 v98, v98, v126, vcc
    v_cndmask_b32 v99, v99, v127, vcc
    v_mov_b32 v47, 0xfffff000
    v_add_u32 v96, 0x800, v96
    v_and_or_b32 v96, v96, v47, s6
    s_mul_i32 s56, s54, 13824
    s_lshl_b32 s57, s53, 9
    s_add_u32 s56, s56, s57
    s_add_u32 s56, s56, 4096
    v_lshlrev_b32 v45, 6, v44
    v_lshrrev_b32 v46, 4, v0
    v_lshl_add_u32 v45, v46, 4, v45
    v_add_u32 v45, s56, v45
    v_cmp_gt_u32 vcc, 8, v44
    s_nop 0
    s_and_saveexec_b64 s[56:57], vcc
    global_store_dwordx4 v45, v[96:99], s[34:35] sc1
    s_mov_b64 exec, -1
    s_branch Lc_hopB
Lc_qprod:
    s_waitcnt vmcnt(2)
    v_mov_b32 v30, 0
    v_mov_b32 v31, 0
    v_lshlrev_b32 v32, 16, v8
    v_and_b32 v33, 0xffff0000, v8
    v_add_f32 v30, v30, v32
    v_fmac_f32 v31, v32, v32
    v_add_f32 v30, v30, v33
    v_fmac_f32 v31, v33, v33
    v_lshlrev_b32 v32, 16, v9
    v_and_b32 v33, 0xffff0000, v9
    v_add_f32 v30, v30, v32
    v_fmac_f32 v31, v32, v32
    v_add_f32 v30, v30, v33
    v_fmac_f32 v31, v33, v33
    v_lshlrev_b32 v32, 16, v10
    v_and_b32 v33, 0xffff0000, v10
    v_add_f32 v30, v30, v32
    v_fmac_f32 v31, v32, v32
    v_add_f32 v30, v30, v33
    v_fmac_f32 v31, v33, v33
    v_lshlrev_b32 v32, 16, v11
    v_and_b32 v33, 0xffff0000, v11
    v_add_f32 v30, v30, v32
    v_fmac_f32 v31, v32, v32
    v_add_f32 v30, v30, v33
    v_fmac_f32 v31, v33, v33
    v_lshlrev_b32 v32, 16, v12
    v_and_b32 v33, 0xffff0000, v12
    v_add_f32 v30, v30, v32
    v_fmac_f32 v31, v32, v32
    v_add_f32 v30, v30, v33
    v_fmac_f32 v31, v33, v33
    v_lshlrev_b32 v32, 16, v13
    v_and_b32 v33, 0xffff0000, v13
    v_add_f32 v30, v30, v32
    v_fmac_f32 v31, v32, v32
    v_add_f32 v30, v30, v33
    v_fmac_f32 v31, v33, v33
    v_lshlrev_b32 v32, 16, v14
    v_and_b32 v33, 0xffff0000, v14
    v_add_f32 v30, v30, v32
    v_fmac_f32 v31, v32, v32
    v_add_f32 v30, v30, v33
    v_fmac_f32 v31, v33, v33
    v_lshlrev_b32 v32, 16, v15
    v_and_b32 v33, 0xffff0000, v15
    v_add_f32 v30, v30, v32
    v_fmac_f32 v31, v32, v32
    v_add_f32 v30, v30, v33
    v_fmac_f32 v31, v33, v33
    s_nop 0
    v_add_f32_dpp v30, v30, v30 row_ror:8 row_mask:0xf bank_mask:0xf
    v_add_f32_dpp v31, v31, v31 row_ror:8 row_mask:0xf bank_mask:0xf
    s_nop 0
    v_add_f32_dpp v30, v30, v30 row_ror:4 row_mask:0xf bank_mask:0xf
    v_add_f32_dpp v31, v31, v31 row_ror:4 row_mask:0xf bank_mask:0xf
    s_nop 0
    v_add_f32_dpp v30, v30, v30 row_ror:2 row_mask:0xf bank_mask:0xf
    v_add_f32_dpp v31, v31, v31 row_ror:2 row_mask:0xf bank_mask:0xf
    s_nop 0
    v_add_f32_dpp v30, v30, v30 row_ror:1 row_mask:0xf bank_mask:0xf
    v_add_f32_dpp v31, v31, v31 row_ror:1 row_mask:0xf bank_mask:0xf
    v_mov_b32 v32, v30
    v_mov_b32 v33, v31
    s_nop 0
    v_permlane16_swap_b32 v32, v30
    v_permlane16_swap_b32 v33, v31
    v_add_f32 v30, v30, v32
    v_add_f32 v31, v31, v33
    v_mov_b32 v32, v30
    v_mov_b32 v33, v31
    s_nop 0
    v_permlane32_swap_b32 v32, v30
    v_permlane32_swap_b32 v33, v31
    v_add_f32 v30, v30, v32
    v_add_f32 v31, v31, v33
    v_mov_b32 v35, 0x3ae38e39
    v_mul_f32 v34, v30, v35
    v_mul_f32 v31, v31, v35
    v_fma_f32 v31, -v34, v34, v31
    v_max_f32 v31, 0, v31
    v_cvt_pk_bf16_f32 v34, v34, v34
    v_cvt_pk_bf16_f32 v31, v31, v31
    v_and_b32 v34, 0xffff0000, v34
    v_and_b32 v31, 0xffff0000, v31
    v_add_f32 v31, 0x3727c5ac, v31
    v_cvt_pk_bf16_f32 v31, v31, v31
    v_and_b32 v31, 0xffff0000, v31
    v_sqrt_f32 v31, v31
    s_nop 0
    v_cvt_pk_bf16_f32 v31, v31, v31
    v_and_b32 v31, 0xffff0000, v31
    v_rcp_f32 v35, v31
    v_lshlrev_b32 v36, 16, v24
    v_and_b32 v37, 0xffff0000, v24
    v_lshlrev_b32 v38, 16, v25
    v_and_b32 v39, 0xffff0000, v25
    v_sub_f32 v36, v36, v34
    v_sub_f32 v37, v37, v34
    v_sub_f32 v38, v38, v34
    v_sub_f32 v39, v39, v34
    v_cvt_pk_bf16_f32 v36, v36, v36
    v_cvt_pk_bf16_f32 v37, v37, v37
    v_cvt_pk_bf16_f32 v38, v38, v38
    v_cvt_pk_bf16_f32 v39, v39, v39
    v_and_b32 v36, 0xffff0000, v36
    v_and_b32 v37, 0xffff0000, v37
    v_and_b32 v38, 0xffff0000, v38
    v_and_b32 v39, 0xffff0000, v39
    v_mul_f32 v36, v36, v35
    v_mul_f32 v37, v37, v35
    v_mul_f32 v38, v38, v35
    v_mul_f32 v39, v39, v35
    v_cvt_pk_bf16_f32 v36, v36, v36
    v_cvt_pk_bf16_f32 v37, v37, v37
    v_cvt_pk_bf16_f32 v38, v38, v38
    v_cvt_pk_bf16_f32 v39, v39, v39
    v_and_b32 v36, 0xffff0000, v36
    v_and_b32 v37, 0xffff0000, v37
    v_and_b32 v38, 0xffff0000, v38
    v_and_b32 v39, 0xffff0000, v39
    v_and_b32 v44, 31, v0
    v_lshlrev_b32 v45, 2, v44
    ds_bpermute_b32 v36, v45, v36
    ds_bpermute_b32 v37, v45, v37
    ds_bpermute_b32 v38, v45, v38
    ds_bpermute_b32 v39, v45, v39
    v_lshrrev_b32 v47, 4, v0
    v_bfe_u32 v45, v0, 2, 2
    v_lshl_add_u32 v46, v47, 3, v45
    v_lshlrev_b32 v46, 7, v46
    v_and_b32 v47, 1, v47
    v_lshrrev_b32 v45, 1, v45
    v_lshl_or_b32 v45, v47, 1, v45
    v_lshlrev_b32 v45, 5, v45
    v_and_b32 v47, 3, v0
    v_lshl_add_u32 v46, v47, 3, v46
    v_add_u32 v46, 110592, v46
    v_xor_b32 v47, 0, v45
    v_add_u32 v60, v46, v47
    v_xor_b32 v47, 32, v45
    v_add_u32 v61, v46, v47
    v_xor_b32 v47, 64, v45
    v_add_u32 v62, v46, v47
    v_xor_b32 v47, 96, v45
    v_add_u32 v63, v46, v47
    v_lshrrev_b32 v44, 4, v0
    v_lshlrev_b32 v49, 4, v44
    v_add_u32 v49, 159808, v49
    v_and_b32 v44, 31, v0
    v_lshlrev_b32 v52, 4, v44
    v_lshrrev_b32 v53, 5, v0
    s_mov_b32 s56, 13824
    v_mul_lo_u32 v53, v53, s56
    v_add_u32 v52, v52, v53
    s_mul_i32 s56, s4, 384
    s_add_u32 s56, s56, 4096
    v_add_u32 v52, s56, v52
    v_add_u32 v53, 27648, v52
    v_add_u32 v54, 55296, v52
    s_mul_i32 s56, s4, 96
    s_lshr_b32 s57, s56, 7
    s_add_u32 s56, s56, 576
    s_lshr_b32 s56, s56, 7
    v_mov_b32 v30, s57
    v_mov_b32 v31, s56
    v_cmp_gt_u32 vcc, 6, v0
    s_nop 1
    v_cndmask_b32 v30, v31, v30, vcc
    v_subrev_u32 v31, 6, v0
    v_cndmask_b32 v31, v31, v0, vcc
    v_min_u32 v31, 5, v31
    v_mul_u32_u24 v30, 6, v30
    v_add_u32 v30, v30, v31
    v_lshlrev_b32 v30, 7, v30
    v_add_u32 v30, 933888, v30
    s_mov_b32 exec_lo, 4095
    s_mov_b32 exec_hi, 0
    s_or_b32 s62, s6, 0x5a5a5000
    s_mov_b32 s59, 0
Lhu_2:
    global_load_dword v31, v30, s[34:35] sc1
    s_waitcnt vmcnt(0)
    v_cmp_ne_u32 vcc, s62, v31
    s_cbranch_vccz Lhud_3
    s_add_u32 s59, s59, 1
    s_cmp_lt_u32 s59, 0x100000
    s_cbranch_scc1 Lhu_2
    s_endpgm
Lhud_3:
    s_mov_b64 exec, -1
    s_mov_b32 exec_lo, 16777215
    s_mov_b32 exec_hi, 16777215
    s_mov_b32 s59, 0
Lpoll_4:
    global_load_dwordx4 v[100:103], v52, s[34:35] sc1
    global_load_dwordx4 v[112:115], v52, s[34:35] offset:2304 sc1
    global_load_dwordx4 v[104:107], v53, s[34:35] sc1
    global_load_dwordx4 v[116:119], v53, s[34:35] offset:2304 sc1
    global_load_dwordx4 v[108:111], v54, s[34:35] sc1
    global_load_dwordx4 v[120:123], v54, s[34:35] offset:2304 sc1
    s_waitcnt vmcnt(0)
    v_xor_b32 v100, s6, v100
    v_xor_b32 v104, s6, v104
    v_xor_b32 v108, s6, v108
    v_xor_b32 v112, s6, v112
    v_xor_b32 v116, s6, v116
    v_xor_b32 v120, s6, v120
    v_or3_b32 v55, v100, v104, v108
    v_or3_b32 v55, v112, v116, v55
    v_or_b32 v55, v120, v55
    v_and_b32 v55, 0xfff, v55
    v_cmp_ne_u32 vcc, 0, v55
    s_cbranch_vccz Lgot_5
    s_add_u32 s59, s59, 1
    s_cmp_lt_u32 s59, 0x100000
    s_cbranch_scc1 Lpoll_4
    s_endpgm
Lgot_5:
    v_pk_add_f32 v[100:101], v[100:101], v[104:105]
    v_pk_add_f32 v[102:103], v[102:103], v[106:107]
    v_pk_add_f32 v[112:113], v[112:113], v[116:117]
    v_pk_add_f32 v[114:115], v[114:115], v[118:119]
    v_pk_add_f32 v[100:101], v[100:101], v[108:109]
    v_pk_add_f32 v[102:103], v[102:103], v[110:111]
    v_pk_add_f32 v[112:113], v[112:113], v[120:121]
    v_pk_add_f32 v[114:115], v[114:115], v[122:123]
    s_mov_b64 exec, -1
    v_mov_b32 v104, v100
    v_mov_b32 v105, v101
    v_mov_b32 v106, v102
    v_mov_b32 v107, v103
    v_mov_b32 v116, v112
    v_mov_b32 v117, v113
    v_mov_b32 v118, v114
    v_mov_b32 v119, v115
    v_permlane32_swap_b32 v104, v100
    v_permlane32_swap_b32 v105, v101
    v_permlane32_swap_b32 v106, v102
    v_permlane32_swap_b32 v107, v103
    v_permlane32_swap_b32 v116, v112
    v_permlane32_swap_b32 v117, v113
    v_permlane32_swap_b32 v118, v114
    v_permlane32_swap_b32 v119, v115
    v_add_f32 v100, v100, v104
    v_add_f32 v101, v101, v105
    v_add_f32 v102, v102, v106
    v_add_f32 v103, v103, v107
    v_add_f32 v112, v112, v116
    v_add_f32 v113, v113, v117
    v_add_f32 v114, v114, v118
    v_add_f32 v115, v115, v119
    v_cvt_pk_bf16_f32 v100, v100, v100
    v_cvt_pk_bf16_f32 v101, v101, v101
    v_cvt_pk_bf16_f32 v102, v102, v102
    v_cvt_pk_bf16_f32 v103, v103, v103
    v_cvt_pk_bf16_f32 v112, v112, v112
    v_cvt_pk_bf16_f32 v113, v113, v113
    v_cvt_pk_bf16_f32 v114, v114, v114
    v_cvt_pk_bf16_f32 v115, v115, v115
    v_and_b32 v100, 0xffff0000, v100
    v_and_b32 v101, 0xffff0000, v101
    v_and_b32 v102, 0xffff0000, v102
    v_and_b32 v103, 0xffff0000, v103
    v_and_b32 v112, 0xffff0000, v112
    v_and_b32 v113, 0xffff0000, v113
    v_and_b32 v114, 0xffff0000, v114
    v_and_b32 v115, 0xffff0000, v115
    v_add_f32 v112, 1.0, v112
    v_add_f32 v113, 1.0, v113
    v_add_f32 v114, 1.0, v114
    v_add_f32 v115, 1.0, v115
    v_cvt_pk_bf16_f32 v112, v112, v112
    v_cvt_pk_bf16_f32 v113, v113, v113
    v_cvt_pk_bf16_f32 v114, v114, v114
    v_cvt_pk_bf16_f32 v115, v115, v115
    v_and_b32 v112, 0xffff0000, v112
    v_and_b32 v113, 0xffff0000, v113
    v_and_b32 v114, 0xffff0000, v114
    v_and_b32 v115, 0xffff0000, v115
    s_waitcnt lgkmcnt(0)
    v_mul_f32 v112, v36, v112
    v_mul_f32 v113, v37, v113
    v_mul_f32 v114, v38, v114
    v_mul_f32 v115, v39, v115
    v_cvt_pk_bf16_f32 v112, v112, v112
    v_cvt_pk_bf16_f32 v113, v113, v113
    v_cvt_pk_bf16_f32 v114, v114, v114
    v_cvt_pk_bf16_f32 v115, v115, v115
    v_and_b32 v112, 0xffff0000, v112
    v_and_b32 v113, 0xffff0000, v113
    v_and_b32 v114, 0xffff0000, v114
    v_and_b32 v115, 0xffff0000, v115
    v_add_f32 v112, v112, v100
    v_add_f32 v113, v113, v101
    v_add_f32 v114, v114, v102
    v_add_f32 v115, v115, v103
    v_cvt_pk_bf16_f32 v112, v112, v113
    v_cvt_pk_bf16_f32 v113, v114, v115
    v_lshlrev_b32 v45, 3, v0
    v_add_u32 v45, 159808, v45
    s_mov_b32 exec_lo, 16777215
    s_mov_b32 exec_hi, 0
    ds_write_b64 v45, v[112:113]
    s_mov_b64 exec, -1
    s_mul_i32 s56, s5, 6
    s_add_u32 s56, s56, s4
    s_lshl_b32 s56, s56, 7
    s_add_u32 s56, s56, 950272
    v_mov_b32 v30, s56
    s_or_b32 s57, s6, 0x5a5a5000
    v_mov_b32 v31, s57
    s_mov_b64 exec, 1
    global_store_dword v30, v31, s[34:35] sc1
    s_mov_b64 exec, -1
    v_mov_b32 v50, 159744
    s_mov_b32 s59, 0
Lwf_6:
    s_add_u32 s59, s59, 1
    s_cmp_lt_u32 s59, 0x1000000
    s_cbranch_scc0 Lend
    ds_read_b32 v51, v50 offset:0
    s_waitcnt lgkmcnt(0)
    v_readfirstlane_b32 s56, v51
    s_nop 0
    s_cmp_lt_u32 s56, 4
    s_cbranch_scc1 Lwf_6
    ds_read_b128 v[64:67], v49 offset:0
    ds_read_b128 v[68:71], v49 offset:64
    ds_read_b128 v[72:75], v49 offset:128
    ds_read_b64_tr_b16 v[128:129], v60 offset:0
    ds_read_b64_tr_b16 v[130:131], v60 offset:512
    ds_read_b64_tr_b16 v[132:133], v61 offset:0
    ds_read_b64_tr_b16 v[134:135], v61 offset:512
    ds_read_b64_tr_b16 v[136:137], v62 offset:0
    ds_read_b64_tr_b16 v[138:139], v62 offset:512
    ds_read_b64_tr_b16 v[140:141], v63 offset:0
    ds_read_b64_tr_b16 v[142:143], v63 offset:512
    s_waitcnt lgkmcnt(0)
    ds_read_b64_tr_b16 v[144:145], v60 offset:4096
    ds_read_b64_tr_b16 v[146:147], v60 offset:4608
    ds_read_b64_tr_b16 v[148:149], v61 offset:4096
    ds_read_b64_tr_b16 v[150:151], v61 offset:4608
    ds_read_b64_tr_b16 v[152:153], v62 offset:4096
    ds_read_b64_tr_b16 v[154:155], v62 offset:4608
    ds_read_b64_tr_b16 v[156:157], v63 offset:4096
    ds_read_b64_tr_b16 v[158:159], v63 offset:4608
    v_mfma_f32_16x16x32_bf16 v[96:99], v[128:131], v[64:67], 0
    v_mfma_f32_16x16x32_bf16 v[100:103], v[132:135], v[64:67], 0
    v_mfma_f32_16x16x32_bf16 v[104:107], v[136:139], v[64:67], 0
    v_mfma_f32_16x16x32_bf16 v[108:111], v[140:143], v[64:67], 0
    s_waitcnt lgkmcnt(0)
    ds_read_b64_tr_b16 v[128:129], v60 offset:8192
    ds_read_b64_tr_b16 v[130:131], v60 offset:8704
    ds_read_b64_tr_b16 v[132:133], v61 offset:8192
    ds_read_b64_tr_b16 v[134:135], v61 offset:8704
    ds_read_b64_tr_b16 v[136:137], v62 offset:8192
    ds_read_b64_tr_b16 v[138:139], v62 offset:8704
    ds_read_b64_tr_b16 v[140:141], v63 offset:8192
    ds_read_b64_tr_b16 v[142:143], v63 offset:8704
    v_mfma_f32_16x16x32_bf16 v[96:99], v[144:147], v[68:71], v[96:99]
    v_mfma_f32_16x16x32_bf16 v[100:103], v[148:151], v[68:71], v[100:103]
    v_mfma_f32_16x16x32_bf16 v[104:107], v[152:155], v[68:71], v[104:107]
    v_mfma_f32_16x16x32_bf16 v[108:111], v[156:159], v[68:71], v[108:111]
    s_waitcnt lgkmcnt(0)
    ds_read_b64_tr_b16 v[144:145], v60 offset:12288
    ds_read_b64_tr_b16 v[146:147], v60 offset:12800
    ds_read_b64_tr_b16 v[148:149], v61 offset:12288
    ds_read_b64_tr_b16 v[150:151], v61 offset:12800
    ds_read_b64_tr_b16 v[152:153], v62 offset:12288
    ds_read_b64_tr_b16 v[154:155], v62 offset:12800
    ds_read_b64_tr_b16 v[156:157], v63 offset:12288
    ds_read_b64_tr_b16 v[158:159], v63 offset:12800
    v_mfma_f32_16x16x32_bf16 v[96:99], v[128:131], v[72:75], v[96:99]
    v_mfma_f32_16x16x32_bf16 v[100:103], v[132:135], v[72:75], v[100:103]
    v_mfma_f32_16x16x32_bf16 v[104:107], v[136:139], v[72:75], v[104:107]
    v_mfma_f32_16x16x32_bf16 v[108:111], v[140:143], v[72:75], v[108:111]
    s_waitcnt lgkmcnt(0)
    ds_read_b64_tr_b16 v[128:129], v60 offset:16384
    ds_read_b64_tr_b16 v[130:131], v60 offset:16896
    ds_read_b64_tr_b16 v[132:133], v61 offset:16384
    ds_read_b64_tr_b16 v[134:135], v61 offset:16896
    ds_read_b64_tr_b16 v[136:137], v62 offset:16384
    ds_read_b64_tr_b16 v[138:139], v62 offset:16896
    ds_read_b64_tr_b16 v[140:141], v63 offset:16384
    ds_read_b64_tr_b16 v[142:143], v63 offset:16896
    v_mfma_f32_16x16x32_bf16 v[112:115], v[144:147], v[64:67], 0
    v_mfma_f32_16x16x32_bf16 v[116:119], v[148:151], v[64:67], 0
    v_mfma_f32_16x16x32_bf16 v[120:123], v[152:155], v[64:67], 0
    v_mfma_f32_16x16x32_bf16 v[124:127], v[156:159], v[64:67], 0
    s_waitcnt lgkmcnt(0)
    ds_read_b64_tr_b16 v[144:145], v60 offset:20480
    ds_read_b64_tr_b16 v[146:147], v60 offset:20992
    ds_read_b64_tr_b16 v[148:149], v61 offset:20480
    ds_read_b64_tr_b16 v[150:151], v61 offset:20992
    ds_read_b64_tr_b16 v[152:153], v62 offset:20480
    ds_read_b64_tr_b16 v[154:155], v62 offset:20992
    ds_read_b64_tr_b16 v[156:157], v63 offset:20480
    ds_read_b64_tr_b16 v[158:159], v63 offset:20992
    v_mfma_f32_16x16x32_bf16 v[112:115], v[128:131], v[68:71], v[112:115]
    v_mfma_f32_16x16x32_bf16 v[116:119], v[132:135], v[68:71], v[116:119]
    v_mfma_f32_16x16x32_bf16 v[120:123], v[136:139], v[68:71], v[120:123]
    v_mfma_f32_16x16x32_bf16 v[124:127], v[140:143], v[68:71], v[124:127]
    s_waitcnt lgkmcnt(0)
    v_mfma_f32_16x16x32_bf16 v[112:115], v[144:147], v[72:75], v[112:115]
    v_mfma_f32_16x16x32_bf16 v[116:119], v[148:151], v[72:75], v[116:119]
    v_mfma_f32_16x16x32_bf16 v[120:123], v[152:155], v[72:75], v[120:123]
    v_mfma_f32_16x16x32_bf16 v[124:127], v[156:159], v[72:75], v[124:127]
    v_and_b32 v44, 15, v0
    v_cmp_eq_u32 vcc, 1, v44
    s_nop 1
    v_cndmask_b32 v96, v96, v100, vcc
    v_cndmask_b32 v97, v97, v101, vcc
    v_cndmask_b32 v98, v98, v102, vcc
    v_cndmask_b32 v99, v99, v103, vcc
    v_cmp_eq_u32 vcc, 2, v44
    s_nop 1
    v_cndmask_b32 v96, v96, v104, vcc
    v_cndmask_b32 v97, v97, v105, vcc
    v_cndmask_b32 v98, v98, v106, vcc
    v_cndmask_b32 v99, v99, v107, vcc
    v_cmp_eq_u32 vcc, 3, v44
    s_nop 1
    v_cndmask_b32 v96, v96, v108, vcc
    v_cndmask_b32 v97, v97, v109, vcc
    v_cndmask_b32 v98, v98, v110, vcc
    v_cndmask_b32 v99, v99, v111, vcc
    v_cmp_eq_u32 vcc, 4, v44
    s_nop 1
    v_cndmask_b32 v96, v96, v112, vcc
    v_cndmask_b32 v97, v97, v113, vcc
    v_cndmask_b32 v98, v98, v114, vcc
    v_cndmask_b32 v99, v99, v115, vcc
    v_cmp_eq_u32 vcc, 5, v44
    s_nop 1
    v_cndmask_b32 v96, v96, v116, vcc
    v_cndmask_b32 v97, v97, v117, vcc
    v_cndmask_b32 v98, v98, v118, vcc
    v_cndmask_b32 v99, v99, v119, vcc
    v_cmp_eq_u32 vcc, 6, v44
    s_nop 1
    v_cndmask_b32 v96, v96, v120, vcc
    v_cndmask_b32 v97, v97, v121, vcc
    v_cndmask_b32 v98, v98, v122, vcc
    v_cndmask_b32 v99, v99, v123, vcc
    v_cmp_eq_u32 vcc, 7, v44
    s_nop 1
    v_cndmask_b32 v96, v96, v124, vcc
    v_cndmask_b32 v97, v97, v125, vcc
    v_cndmask_b32 v98, v98, v126, vcc
    v_cndmask_b32 v99, v99, v127, vcc
    v_mov_b32 v47, 0xfffff000
    v_add_u32 v96, 0x800, v96
    v_and_or_b32 v96, v96, v47, s6
    s_mul_i32 s56, s5, 6
    s_add_u32 s56, s56, s4
    s_lshl_b32 s56, s56, 9
    s_add_u32 s56, s56, 98304
    v_lshlrev_b32 v45, 6, v44
    v_lshrrev_b32 v46, 4, v0
    v_lshl_add_u32 v45, v46, 4, v45
    v_add_u32 v45, s56, v45
    v_cmp_gt_u32 vcc, 8, v44
    s_nop 0
    s_and_saveexec_b64 s[56:57], vcc
    global_store_dwordx4 v45, v[96:99], s[34:35] sc1
    s_mov_b64 exec, -1
Lc_hopB:
    v_and_b32 v44, 31, v0
    v_lshlrev_b32 v44, 4, v44
    v_lshrrev_b32 v45, 5, v0
    v_lshl_add_u32 v44, v45, 9, v44
    s_mul_i32 s56, s5, 3072
    s_add_u32 s56, s56, 98304
    v_add_u32 v44, s56, v44
    s_mov_b32 s64, s56
    s_mul_i32 s56, s5, 768
    s_add_u32 s56, s56, 950272
    v_lshlrev_b32 v30, 7, v0
    v_add_u32 v30, s56, v30
    s_mov_b32 exec_lo, 63
    s_mov_b32 exec_hi, 0
    s_or_b32 s62, s6, 0x5a5a5000
    s_mov_b32 s59, 0
Lhu_7:
    global_load_dword v31, v30, s[34:35] sc1
    s_waitcnt vmcnt(0)
    v_cmp_ne_u32 vcc, s62, v31
    s_cbranch_vccz Lhud_8
    s_add_u32 s59, s59, 1
    s_cmp_lt_u32 s59, 0x100000
    s_cbranch_scc1 Lhu_7
    s_endpgm
Lhud_8:
    s_mov_b64 exec, -1
    s_mov_b32 s59, 0
Lpoll_9:
    global_load_dwordx4 v[52:55], v44, s[34:35] sc1
    global_load_dwordx4 v[56:59], v44, s[34:35] offset:1024 sc1
    global_load_dwordx4 v[60:63], v44, s[34:35] offset:2048 sc1
    s_waitcnt vmcnt(0)
    v_xor_b32 v52, s6, v52
    v_xor_b32 v56, s6, v56
    v_xor_b32 v60, s6, v60
    v_or3_b32 v45, v52, v56, v60
    v_and_b32 v45, 0xfff, v45
    v_cmp_ne_u32 vcc, 0, v45
    s_cbranch_vccz Lgot_10
    s_add_u32 s59, s59, 1
    s_cmp_lt_u32 s59, 0x100000
    s_cbranch_scc1 Lpoll_9
    s_endpgm
Lgot_10:
    v_pk_add_f32 v[52:53], v[52:53], v[56:57]
    v_pk_add_f32 v[54:55], v[54:55], v[58:59]
    v_pk_add_f32 v[52:53], v[52:53], v[60:61]
    v_pk_add_f32 v[54:55], v[54:55], v[62:63]
    v_mov_b32 v56, v52
    v_mov_b32 v57, v53
    v_mov_b32 v58, v54
    v_mov_b32 v59, v55
    v_permlane32_swap_b32 v56, v52
    v_permlane32_swap_b32 v57, v53
    v_permlane32_swap_b32 v58, v54
    v_permlane32_swap_b32 v59, v55
    v_add_f32 v52, v52, v56
    v_add_f32 v53, v53, v57
    v_add_f32 v54, v54, v58
    v_add_f32 v55, v55, v59
    v_cvt_pk_bf16_f32 v52, v52, v53
    v_cvt_pk_bf16_f32 v53, v54, v55
    v_and_b32 v44, 31, v0
    v_lshlrev_b32 v44, 3, v44
    v_add_u32 v44, 160192, v44
    ds_write_b64 v44, v[52:53]
    s_waitcnt lgkmcnt(0)
    v_mov_b32 v50, 159744
    v_mov_b32 v51, 1
    s_mov_b64 exec, 1
    ds_write_b32 v50, v51 offset:12
    s_mov_b64 exec, -1
    s_setprio 0
    s_cmp_eq_u32 s72, 1
    s_cbranch_scc0 Lpre
    v_lshlrev_b32 v40, 16, v18
    v_and_b32 v41, 0xffff0000, v18
    v_lshlrev_b32 v42, 16, v19
    v_and_b32 v43, 0xffff0000, v19
    v_mul_f32 v44, 0xbfb8aa3b, v40
    v_mul_f32 v45, 0xbfb8aa3b, v41
    v_mul_f32 v46, 0xbfb8aa3b, v42
    v_mul_f32 v47, 0xbfb8aa3b, v43
    v_exp_f32 v44, v44
    v_exp_f32 v45, v45
    v_exp_f32 v46, v46
    v_exp_f32 v47, v47
    v_add_f32 v44, 1.0, v44
    v_add_f32 v45, 1.0, v45
    v_add_f32 v46, 1.0, v46
    v_add_f32 v47, 1.0, v47
    v_rcp_f32 v44, v44
    v_rcp_f32 v45, v45
    v_rcp_f32 v46, v46
    v_rcp_f32 v47, v47
    v_mul_f32 v40, v40, v44
    v_mul_f32 v41, v41, v45
    v_mul_f32 v42, v42, v46
    v_mul_f32 v43, v43, v47
    v_cvt_pk_bf16_f32 v40, v40, v41
    v_cvt_pk_bf16_f32 v41, v42, v43
    v_lshlrev_b32 v42, 3, v0
    v_add_u32 v42, 160000, v42
    s_mov_b32 exec_lo, 16777215
    s_mov_b32 exec_hi, 0
    ds_write_b64 v42, v[40:41]
    s_mov_b64 exec, -1
    v_lshrrev_b32 v47, 4, v0
    v_bfe_u32 v45, v0, 2, 2
    v_lshl_add_u32 v46, v47, 3, v45
    v_lshlrev_b32 v46, 7, v46
    v_and_b32 v47, 1, v47
    v_lshrrev_b32 v45, 1, v45
    v_lshl_or_b32 v45, v47, 1, v45
    v_lshlrev_b32 v45, 5, v45
    v_and_b32 v47, 3, v0
    v_lshl_add_u32 v46, v47, 3, v46
    v_add_u32 v46, s75, v46
    v_xor_b32 v47, 0, v45
    v_add_u32 v60, v46, v47
    v_xor_b32 v47, 32, v45
    v_add_u32 v61, v46, v47
    v_xor_b32 v47, 64, v45
    v_add_u32 v62, v46, v47
    v_xor_b32 v47, 96, v45
    v_add_u32 v63, v46, v47
    v_lshrrev_b32 v44, 4, v0
    v_lshlrev_b32 v49, 4, v44
    v_add_u32 v49, 160000, v49
    v_mov_b32 v50, 159744
    s_mov_b32 s59, 0
Lwf_11:
    s_add_u32 s59, s59, 1
    s_cmp_lt_u32 s59, 0x1000000
    s_cbranch_scc0 Lend
    ds_read_b32 v51, v50 offset:4
    s_waitcnt lgkmcnt(0)
    v_readfirstlane_b32 s56, v51
    s_nop 0
    s_cmp_lt_u32 s56, 2
    s_cbranch_scc1 Lwf_11
    ds_read_b128 v[64:67], v49 offset:0
    ds_read_b128 v[68:71], v49 offset:64
    ds_read_b128 v[72:75], v49 offset:128
    ds_read_b64_tr_b16 v[128:129], v60 offset:0
    ds_read_b64_tr_b16 v[130:131], v60 offset:512
    ds_read_b64_tr_b16 v[132:133], v61 offset:0
    ds_read_b64_tr_b16 v[134:135], v61 offset:512
    ds_read_b64_tr_b16 v[136:137], v62 offset:0
    ds_read_b64_tr_b16 v[138:139], v62 offset:512
    ds_read_b64_tr_b16 v[140:141], v63 offset:0
    ds_read_b64_tr_b16 v[142:143], v63 offset:512
    s_waitcnt lgkmcnt(0)
    ds_read_b64_tr_b16 v[144:145], v60 offset:4096
    ds_read_b64_tr_b16 v[146:147], v60 offset:4608
    ds_read_b64_tr_b16 v[148:149], v61 offset:4096
    ds_read_b64_tr_b16 v[150:151], v61 offset:4608
    ds_read_b64_tr_b16 v[152:153], v62 offset:4096
    ds_read_b64_tr_b16 v[154:155], v62 offset:4608
    ds_read_b64_tr_b16 v[156:157], v63 offset:4096
    ds_read_b64_tr_b16 v[158:159], v63 offset:4608
    v_mfma_f32_16x16x32_bf16 v[96:99], v[128:131], v[64:67], 0
    v_mfma_f32_16x16x32_bf16 v[100:103], v[132:135], v[64:67], 0
    v_mfma_f32_16x16x32_bf16 v[104:107], v[136:139], v[64:67], 0
    v_mfma_f32_16x16x32_bf16 v[108:111], v[140:143], v[64:67], 0
    s_waitcnt lgkmcnt(0)
    ds_read_b64_tr_b16 v[128:129], v60 offset:8192
    ds_read_b64_tr_b16 v[130:131], v60 offset:8704
    ds_read_b64_tr_b16 v[132:133], v61 offset:8192
    ds_read_b64_tr_b16 v[134:135], v61 offset:8704
    ds_read_b64_tr_b16 v[136:137], v62 offset:8192
    ds_read_b64_tr_b16 v[138:139], v62 offset:8704
    ds_read_b64_tr_b16 v[140:141], v63 offset:8192
    ds_read_b64_tr_b16 v[142:143], v63 offset:8704
    v_mfma_f32_16x16x32_bf16 v[96:99], v[144:147], v[68:71], v[96:99]
    v_mfma_f32_16x16x32_bf16 v[100:103], v[148:151], v[68:71], v[100:103]
    v_mfma_f32_16x16x32_bf16 v[104:107], v[152:155], v[68:71], v[104:107]
    v_mfma_f32_16x16x32_bf16 v[108:111], v[156:159], v[68:71], v[108:111]
    s_waitcnt lgkmcnt(0)
    ds_read_b64_tr_b16 v[144:145], v60 offset:12288
    ds_read_b64_tr_b16 v[146:147], v60 offset:12800
    ds_read_b64_tr_b16 v[148:149], v61 offset:12288
    ds_read_b64_tr_b16 v[150:151], v61 offset:12800
    ds_read_b64_tr_b16 v[152:153], v62 offset:12288
    ds_read_b64_tr_b16 v[154:155], v62 offset:12800
    ds_read_b64_tr_b16 v[156:157], v63 offset:12288
    ds_read_b64_tr_b16 v[158:159], v63 offset:12800
    v_mfma_f32_16x16x32_bf16 v[96:99], v[128:131], v[72:75], v[96:99]
    v_mfma_f32_16x16x32_bf16 v[100:103], v[132:135], v[72:75], v[100:103]
    v_mfma_f32_16x16x32_bf16 v[104:107], v[136:139], v[72:75], v[104:107]
    v_mfma_f32_16x16x32_bf16 v[108:111], v[140:143], v[72:75], v[108:111]
    s_waitcnt lgkmcnt(0)
    ds_read_b64_tr_b16 v[128:129], v60 offset:16384
    ds_read_b64_tr_b16 v[130:131], v60 offset:16896
    ds_read_b64_tr_b16 v[132:133], v61 offset:16384
    ds_read_b64_tr_b16 v[134:135], v61 offset:16896
    ds_read_b64_tr_b16 v[136:137], v62 offset:16384
    ds_read_b64_tr_b16 v[138:139], v62 offset:16896
    ds_read_b64_tr_b16 v[140:141], v63 offset:16384
    ds_read_b64_tr_b16 v[142:143], v63 offset:16896
    v_mfma_f32_16x16x32_bf16 v[112:115], v[144:147], v[64:67], 0
    v_mfma_f32_16x16x32_bf16 v[116:119], v[148:151], v[64:67], 0
    v_mfma_f32_16x16x32_bf16 v[120:123], v[152:155], v[64:67], 0
    v_mfma_f32_16x16x32_bf16 v[124:127], v[156:159], v[64:67], 0
    s_waitcnt lgkmcnt(0)
    ds_read_b64_tr_b16 v[144:145], v60 offset:20480
    ds_read_b64_tr_b16 v[146:147], v60 offset:20992
    ds_read_b64_tr_b16 v[148:149], v61 offset:20480
    ds_read_b64_tr_b16 v[150:151], v61 offset:20992
    ds_read_b64_tr_b16 v[152:153], v62 offset:20480
    ds_read_b64_tr_b16 v[154:155], v62 offset:20992
    ds_read_b64_tr_b16 v[156:157], v63 offset:20480
    ds_read_b64_tr_b16 v[158:159], v63 offset:20992
    v_mfma_f32_16x16x32_bf16 v[112:115], v[128:131], v[68:71], v[112:115]
    v_mfma_f32_16x16x32_bf16 v[116:119], v[132:135], v[68:71], v[116:119]
    v_mfma_f32_16x16x32_bf16 v[120:123], v[136:139], v[68:71], v[120:123]
    v_mfma_f32_16x16x32_bf16 v[124:127], v[140:143], v[68:71], v[124:127]
    s_waitcnt lgkmcnt(0)
    v_mfma_f32_16x16x32_bf16 v[112:115], v[144:147], v[72:75], v[112:115]
    v_mfma_f32_16x16x32_bf16 v[116:119], v[148:151], v[72:75], v[116:119]
    v_mfma_f32_16x16x32_bf16 v[120:123], v[152:155], v[72:75], v[120:123]
    v_mfma_f32_16x16x32_bf16 v[124:127], v[156:159], v[72:75], v[124:127]
    v_and_b32 v44, 15, v0
    v_cmp_eq_u32 vcc, 1, v44
    s_nop 1
    v_cndmask_b32 v96, v96, v100, vcc
    v_cndmask_b32 v97, v97, v101, vcc
    v_cndmask_b32 v98, v98, v102, vcc
    v_cndmask_b32 v99, v99, v103, vcc
    v_cmp_eq_u32 vcc, 2, v44
    s_nop 1
    v_cndmask_b32 v96, v96, v104, vcc
    v_cndmask_b32 v97, v97, v105, vcc
    v_cndmask_b32 v98, v98, v106, vcc
    v_cndmask_b32 v99, v99, v107, vcc
    v_cmp_eq_u32 vcc, 3, v44
    s_nop 1
    v_cndmask_b32 v96, v96, v108, vcc
    v_cndmask_b32 v97, v97, v109, vcc
    v_cndmask_b32 v98, v98, v110, vcc
    v_cndmask_b32 v99, v99, v111, vcc
    v_cmp_eq_u32 vcc, 4, v44
    s_nop 1
    v_cndmask_b32 v96, v96, v112, vcc
    v_cndmask_b32 v97, v97, v113, vcc
    v_cndmask_b32 v98, v98, v114, vcc
    v_cndmask_b32 v99, v99, v115, vcc
    v_cmp_eq_u32 vcc, 5, v44
    s_nop 1
    v_cndmask_b32 v96, v96, v116, vcc
    v_cndmask_b32 v97, v97, v117, vcc
    v_cndmask_b32 v98, v98, v118, vcc
    v_cndmask_b32 v99, v99, v119, vcc
    v_cmp_eq_u32 vcc, 6, v44
    s_nop 1
    v_cndmask_b32 v96, v96, v120, vcc
    v_cndmask_b32 v97, v97, v121, vcc
    v_cndmask_b32 v98, v98, v122, vcc
    v_cndmask_b32 v99, v99, v123, vcc
    v_cmp_eq_u32 vcc, 7, v44
    s_nop 1
    v_cndmask_b32 v96, v96, v124, vcc
    v_cndmask_b32 v97, v97, v125, vcc
    v_cndmask_b32 v98, v98, v126, vcc
    v_cndmask_b32 v99, v99, v127, vcc
    v_mov_b32 v47, 0xfffff000
    v_add_u32 v96, 0x800, v96
    v_and_or_b32 v96, v96, v47, s6
    s_mul_i32 s56, s74, 13824
    s_lshl_b32 s57, s73, 9
    s_add_u32 s56, s56, s57
    s_add_u32 s56, s56, 4096
    v_lshlrev_b32 v45, 6, v44
    v_lshrrev_b32 v46, 4, v0
    v_lshl_add_u32 v45, v46, 4, v45
    v_add_u32 v45, s56, v45
    v_cmp_gt_u32 vcc, 8, v44
    s_nop 0
    s_and_saveexec_b64 s[56:57], vcc
    global_store_dwordx4 v45, v[96:99], s[34:35] sc1
    s_mov_b64 exec, -1
Lpre:
    s_cmp_lt_u32 s100, 18
    s_cbranch_scc0 Lpre_notffn
    s_cmp_lt_u32 s3, 7
    s_cbranch_scc0 Lpre_dma
    s_sub_u32 s56, s3, 4
    s_lshl_b32 s56, s56, 6
    v_add_u32 v2, s56, v0
    v_cmp_gt_u32 vcc, 144, v2
    s_nop 0
    s_and_b64 exec, vcc, exec
    v_lshlrev_b32 v3, 4, v2
    v_lshlrev_b32 v4, 3, v2
    global_load_dwordx2 v[8:9], v4, s[8:9]
    v_add_u32 v5, 917504, v3
    v_add_u32 v6, 2304, v5
    v_add_u32 v7, 4608, v5
    s_mov_b32 s59, 0
Lpoll_12:
    global_load_dwordx4 v[12:15], v7, s[34:35] sc1
    global_load_dwordx4 v[16:19], v6, s[34:35] sc1
    global_load_dwordx4 v[20:23], v5, s[34:35] sc1
    s_waitcnt vmcnt(0)
    v_xor_b32 v12, s6, v12
    v_xor_b32 v16, s6, v16
    v_xor_b32 v20, s6, v20
    v_or3_b32 v61, v12, v16, v20
    v_and_b32 v61, 0xfff, v61
    v_cmp_ne_u32 vcc, 0, v61
    s_cbranch_vccz Lgot_13
    s_sleep 100
    s_add_u32 s59, s59, 1
    s_cmp_lt_u32 s59, 0x100000
    s_cbranch_scc1 Lpoll_12
    s_endpgm
Lgot_13:
    v_lshlrev_b32 v24, 16, v8
    v_and_b32 v25, 0xffff0000, v8
    v_lshlrev_b32 v26, 16, v9
    v_and_b32 v27, 0xffff0000, v9
    v_cvt_pk_bf16_f32 v28, v12, v13
    v_cvt_pk_bf16_f32 v29, v14, v15
    v_cvt_pk_bf16_f32 v30, v16, v17
    v_cvt_pk_bf16_f32 v31, v18, v19
    v_add_u32 v5, 120960, v4
    v_add_u32 v4, 114048, v3
    ds_write_b128 v4, v[12:15]
    ds_write_b128 v4, v[20:23] offset:2304
    ds_write_b128 v4, v[24:27] offset:4608
    ds_write_b64 v5, v[28:29]
    ds_write_b64 v5, v[30:31] offset:1152
    s_mov_b64 exec, -1
Lpre_dma:
    s_branch Ltail
Lpre_notffn:
    s_cmp_ge_u32 s100, 27
    s_cbranch_scc0 Ltail
    s_sub_u32 s56, s100, 27
    s_lshl_b32 s56, s56, 3
    s_add_u32 s74, s56, s4
    s_cmp_eq_u32 s3, 6
    s_cbranch_scc1 Lpre_red
    s_cmp_eq_u32 s3, 4
    s_cbranch_scc0 Ltail
    s_branch Lpre_fin
Lpre_red:
    s_cmp_lt_u32 s74, 36
    s_cbranch_scc0 Ltail
    v_and_b32 v2, 15, v0
    s_lshl_b32 s56, s74, 4
    v_add_u32 v2, s56, v2
    v_lshrrev_b32 v3, 4, v0
    s_mov_b32 s56, 13824
    v_mul_lo_u32 v4, v3, s56
    v_lshl_add_u32 v4, v2, 4, v4
    v_add_u32 v4, 8704, v4
    v_and_b32 v5, 1, v3
    v_add_u32 v5, 4, v5
    v_mul_lo_u32 v5, v5, s56
    v_lshl_add_u32 v5, v2, 4, v5
    v_add_u32 v5, 8704, v5
    s_mov_b32 s59, 0
Lpoll_14:
    global_load_dwordx4 v[12:15], v4, s[34:35] sc1
    global_load_dwordx4 v[16:19], v5, s[34:35] sc1
    s_waitcnt vmcnt(0)
    v_xor_b32 v12, s6, v12
    v_xor_b32 v16, s6, v16
    v_or_b32 v61, v12, v16
    v_and_b32 v61, 0xfff, v61
    v_cmp_ne_u32 vcc, 0, v61
    s_cbranch_vccz Lgot_15
    s_sleep 40
    s_add_u32 s59, s59, 1
    s_cmp_lt_u32 s59, 0x100000
    s_cbranch_scc1 Lpoll_14
    s_endpgm
Lgot_15:
    v_cmp_gt_u32 vcc, 2, v3
    s_nop 1
    v_cndmask_b32 v16, 0, v16, vcc
    v_cndmask_b32 v17, 0, v17, vcc
    v_cndmask_b32 v18, 0, v18, vcc
    v_cndmask_b32 v19, 0, v19, vcc
    v_pk_add_f32 v[12:13], v[12:13], v[16:17]
    v_pk_add_f32 v[14:15], v[14:15], v[18:19]
    v_mov_b32 v16, v12
    v_mov_b32 v17, v13
    v_mov_b32 v18, v14
    v_mov_b32 v19, v15
    v_permlane16_swap_b32 v16, v12
    v_permlane16_swap_b32 v17, v13
    v_permlane16_swap_b32 v18, v14
    v_permlane16_swap_b32 v19, v15
    v_add_f32 v12, v12, v16
    v_add_f32 v13, v13, v17
    v_add_f32 v14, v14, v18
    v_add_f32 v15, v15, v19
    v_mov_b32 v16, v12
    v_mov_b32 v17, v13
    v_mov_b32 v18, v14
    v_mov_b32 v19, v15
    v_permlane32_swap_b32 v16, v12
    v_permlane32_swap_b32 v17, v13
    v_permlane32_swap_b32 v18, v14
    v_permlane32_swap_b32 v19, v15
    v_add_f32 v12, v12, v16
    v_add_f32 v13, v13, v17
    v_add_f32 v14, v14, v18
    v_add_f32 v15, v15, v19
    v_cvt_pk_bf16_f32 v12, v12, v12
    v_cvt_pk_bf16_f32 v13, v13, v13
    v_cvt_pk_bf16_f32 v14, v14, v14
    v_cvt_pk_bf16_f32 v15, v15, v15
    v_and_b32 v12, 0xffff0000, v12
    v_and_b32 v13, 0xffff0000, v13
    v_and_b32 v14, 0xffff0000, v14
    v_and_b32 v15, 0xffff0000, v15
    v_subrev_u32 v6, 288, v2
    v_cmp_gt_u32 vcc, 144, v6
    v_mov_b32 v7, 0
    v_mov_b32 v8, 1.0
    v_cndmask_b32 v7, v7, v8, vcc
    v_add_f32 v12, v12, v7
    v_add_f32 v13, v13, v7
    v_add_f32 v14, v14, v7
    v_add_f32 v15, v15, v7
    v_cvt_pk_bf16_f32 v12, v12, v12
    v_cvt_pk_bf16_f32 v13, v13, v13
    v_cvt_pk_bf16_f32 v14, v14, v14
    v_cvt_pk_bf16_f32 v15, v15, v15
    v_and_b32 v12, 0xffff0000, v12
    v_and_b32 v13, 0xffff0000, v13
    v_and_b32 v14, 0xffff0000, v14
    v_and_b32 v15, 0xffff0000, v15
    v_or_b32 v12, s6, v12
    v_lshlrev_b32 v4, 4, v2
    v_add_u32 v4, 917504, v4
    s_mov_b32 exec_lo, 65535
    s_mov_b32 exec_hi, 0
    global_store_dwordx4 v4, v[12:15], s[34:35] sc1
    s_mov_b64 exec, -1
    s_branch Ltail
Lpre_fin:
    s_cmp_lt_u32 s74, 36
    s_cbranch_scc0 Ltail
    v_and_b32 v2, 3, v0
    s_lshl_b32 s56, s74, 2
    v_add_u32 v2, s56, v2
    v_lshlrev_b32 v3, 4, v2
    v_lshlrev_b32 v4, 3, v2
    global_load_dwordx2 v[8:9], v4, s[8:9]
    v_add_u32 v5, 917504, v3
    v_add_u32 v6, 6912, v5
    s_mov_b32 s59, 0
Lpoll_16:
    global_load_dwordx4 v[12:15], v5, s[34:35] sc1
    global_load_dwordx4 v[16:19], v6, s[34:35] sc1
    s_waitcnt vmcnt(0)
    v_xor_b32 v12, s6, v12
    v_xor_b32 v16, s6, v16
    v_or_b32 v61, v12, v16
    v_and_b32 v61, 0xfff, v61
    v_cmp_ne_u32 vcc, 0, v61
    s_cbranch_vccz Lgot_17
    s_sleep 100
    s_add_u32 s59, s59, 1
    s_cmp_lt_u32 s59, 0x100000
    s_cbranch_scc1 Lpoll_16
    s_endpgm
Lgot_17:
    v_lshlrev_b32 v24, 16, v8
    v_and_b32 v25, 0xffff0000, v8
    v_lshlrev_b32 v26, 16, v9
    v_and_b32 v27, 0xffff0000, v9
Ltail:
    s_waitcnt vmcnt(0)
    s_barrier
    s_cmp_eq_u32 s3, 0
    s_cbranch_scc0 Lt_role
    v_and_b32 v12, 15, v0
    v_lshlrev_b32 v12, 5, v12
    v_bfe_u32 v13, v0, 4, 1
    v_lshl_add_u32 v12, v13, 4, v12
    v_add_u32 v13, 110592, v12
    v_mov_b32 v14, 112640
    ds_read_b128 v[16:19], v14
    ds_read_b128 v[20:23], v14 offset:16
    ds_read_b128 v[32:35], v13
    ds_read_b128 v[36:39], v13 offset:512
    ds_read_b128 v[40:43], v13 offset:1024
    ds_read_b128 v[44:47], v13 offset:1536
    s_lshl_b32 s56, s2, 10
    s_add_u32 s56, s56, 196608
    v_add_u32 v12, s56, v12
    s_add_u32 s56, s56, 512
    s_waitcnt lgkmcnt(4)
    v_max_f32 v24, v16, v18
    v_max3_f32 v24, v24, v20, v22
    v_sub_f32 v16, v16, v24
    v_sub_f32 v18, v18, v24
    v_sub_f32 v20, v20, v24
    v_sub_f32 v22, v22, v24
    v_mul_f32 v16, s71, v16
    v_mul_f32 v18, s71, v18
    v_mul_f32 v20, s71, v20
    v_mul_f32 v22, s71, v22
    v_exp_f32 v16, v16
    v_exp_f32 v18, v18
    v_exp_f32 v20, v20
    v_exp_f32 v22, v22
    v_mov_b32 v15, 0xfffff000
    v_mul_f32 v25, v16, v17
    v_fmac_f32 v25, v18, v19
    v_fmac_f32 v25, v20, v21
    v_fmac_f32 v25, v22, v23
    s_waitcnt lgkmcnt(0)
    v_mul_f32 v32, v16, v32
    v_mul_f32 v33, v16, v33
    v_mul_f32 v34, v16, v34
    v_mul_f32 v35, v16, v35
    v_fmac_f32 v32, v18, v36
    v_fmac_f32 v33, v18, v37
    v_fmac_f32 v34, v18, v38
    v_fmac_f32 v35, v18, v39
    v_fmac_f32 v32, v20, v40
    v_fmac_f32 v33, v20, v41
    v_fmac_f32 v34, v20, v42
    v_fmac_f32 v35, v20, v43
    v_fmac_f32 v32, v22, v44
    v_fmac_f32 v33, v22, v45
    v_fmac_f32 v34, v22, v46
    v_fmac_f32 v35, v22, v47
    v_add_u32 v24, 0x800, v24
    v_add_u32 v25, 0x800, v25
    v_add_u32 v32, 0x800, v32
    v_and_or_b32 v24, v24, v15, s6
    v_and_or_b32 v25, v25, v15, s6
    v_and_or_b32 v32, v32, v15, s6
    s_mov_b32 exec_lo, 0
    s_mov_b32 exec_hi, 1
    v_mov_b32 v32, v24
    v_mov_b32 v33, v24
    v_mov_b32 v34, v25
    v_mov_b32 v35, v25
    v_mov_b32 v12, s56
    s_mov_b32 exec_lo, -1
    s_mov_b32 exec_hi, 1
    global_store_dwordx4 v12, v[32:35], s[34:35] sc1
    s_mov_b64 exec, -1
Lt_role:
    s_cmp_lt_u32 s100, 18
    s_cbranch_scc1 Lt_ffn
    s_cmp_lt_u32 s100, 27
    s_cbranch_scc1 Lt_wo
    s_branch Lt_final
Lt_wo:
    s_cmp_lt_u32 s3, 4
    s_cbranch_scc0 Lwo_go
    s_barrier
    s_branch Lexit
Lwo_go:
    s_sub_u32 s58, s3, 4
    v_lshrrev_b32 v44, 4, v0
    v_bfe_u32 v45, v0, 2, 2
    v_lshl_add_u32 v46, v44, 3, v45
    v_lshlrev_b32 v46, 7, v46
    v_and_b32 v47, 3, v0
    v_lshl_add_u32 v46, v47, 3, v46
    v_lshrrev_b32 v45, 1, v45
    v_and_b32 v47, 1, v44
    v_lshl_or_b32 v45, v47, 1, v45
    v_xor_b32 v45, s58, v45
    v_lshl_add_u32 v46, v45, 5, v46
    v_add_u32 v46, 0, v46
    ds_read_b64_tr_b16 v[128:129], v46 offset:0
    ds_read_b64_tr_b16 v[130:131], v46 offset:512
    ds_read_b64_tr_b16 v[132:133], v46 offset:4096
    ds_read_b64_tr_b16 v[134:135], v46 offset:4608
    ds_read_b64_tr_b16 v[136:137], v46 offset:8192
    ds_read_b64_tr_b16 v[138:139], v46 offset:8704
    ds_read_b64_tr_b16 v[140:141], v46 offset:12288
    ds_read_b64_tr_b16 v[142:143], v46 offset:12800
    s_waitcnt lgkmcnt(4)
    ds_read_b64_tr_b16 v[144:145], v46 offset:16384
    ds_read_b64_tr_b16 v[146:147], v46 offset:16896
    ds_read_b64_tr_b16 v[148:149], v46 offset:20480
    ds_read_b64_tr_b16 v[150:151], v46 offset:20992
    ds_read_b64_tr_b16 v[152:153], v46 offset:24576
    ds_read_b64_tr_b16 v[154:155], v46 offset:25088
    s_waitcnt lgkmcnt(2)
    ds_read_b64_tr_b16 v[156:157], v46 offset:28672
    ds_read_b64_tr_b16 v[158:159], v46 offset:29184
    ds_read_b64_tr_b16 v[160:161], v46 offset:32768
    ds_read_b64_tr_b16 v[162:163], v46 offset:33280
    ds_read_b64_tr_b16 v[164:165], v46 offset:36864
    ds_read_b64_tr_b16 v[166:167], v46 offset:37376
    ds_read_b64_tr_b16 v[168:169], v46 offset:40960
    ds_read_b64_tr_b16 v[170:171], v46 offset:41472
    ds_read_b64_tr_b16 v[172:173], v46 offset:45056
    ds_read_b64_tr_b16 v[174:175], v46 offset:45568
    s_waitcnt lgkmcnt(4)
    ds_read_b64_tr_b16 v[176:177], v46 offset:49152
    ds_read_b64_tr_b16 v[178:179], v46 offset:49664
    ds_read_b64_tr_b16 v[180:181], v46 offset:53248
    ds_read_b64_tr_b16 v[182:183], v46 offset:53760
    ds_read_b64_tr_b16 v[184:185], v46 offset:57344
    ds_read_b64_tr_b16 v[186:187], v46 offset:57856
    ds_read_b64_tr_b16 v[188:189], v46 offset:61440
    ds_read_b64_tr_b16 v[190:191], v46 offset:61952
    v_lshlrev_b32 v49, 4, v44
    v_add_u32 v49, 160448, v49
    s_lshl_b32 s56, s4, 2
    s_add_u32 s56, s56, s58
    s_lshl_b32 s56, s56, 13
    s_add_u32 s56, s56, 196608
    v_lshrrev_b32 v2, 4, v0
    v_and_b32 v3, 15, v0
    v_lshlrev_b32 v4, 10, v2
    v_add_u32 v4, s56, v4
    v_add_u32 v5, 512, v4
    v_lshl_add_u32 v4, v3, 4, v4
    v_add_u32 v6, 4096, v4
    v_add_u32 v7, 4096, v5
    s_mov_b32 s71, 0x3fb8aa3b
    s_mul_i32 s56, s4, 2304
    s_sub_u32 s57, s100, 18
    s_lshl_b32 s57, s57, 8
    s_add_u32 s56, s56, s57
    s_lshl_b32 s57, s58, 6
    s_add_u32 s56, s56, s57
    s_add_u32 s56, s56, 458752
    v_lshlrev_b32 v45, 4, v44
    v_add_u32 v45, s56, v45
    v_mov_b32 v47, 0xfffff000
    s_lshl_b32 s56, s58, 8
    s_add_u32 s56, s56, 160448
    v_lshl_add_u32 v2, v3, 3, s56
    v_lshrrev_b32 v36, 4, v0
    v_lshl_add_u32 v2, v36, 1, v2
    s_sub_u32 s57, s100, 18
    s_mov_b32 s65, 0
    s_cmp_lt_u32 s57, 8
    s_cselect_b32 s65, 1, 0
    s_cmp_eq_u32 s3, 4
    s_cselect_b32 s65, s65, 0
    s_lshl_b32 s57, s57, 3
    s_add_u32 s57, s57, s4
    s_lshl_b32 s57, s57, 7
    s_add_u32 s57, s57, 892928
    v_mov_b32 v38, s57
    s_or_b32 s57, s6, 0x5a5a5000
    v_mov_b32 v39, s57
    s_waitcnt lgkmcnt(0)
    s_mov_b32 s59, 0
Lpoll_18:
    global_load_dwordx4 v[8:11], v5, s[34:35] sc1
    global_load_dwordx4 v[12:15], v7, s[34:35] sc1
    global_load_dwordx4 v[16:19], v4, s[34:35] sc1
    global_load_dwordx4 v[20:23], v4, s[34:35] offset:256 sc1
    global_load_dwordx4 v[24:27], v6, s[34:35] sc1
    global_load_dwordx4 v[28:31], v6, s[34:35] offset:256 sc1
    s_waitcnt vmcnt(0)
    v_xor_b32 v8, s6, v8
    v_xor_b32 v9, s6, v9
    v_xor_b32 v10, s6, v10
    v_xor_b32 v11, s6, v11
    v_xor_b32 v12, s6, v12
    v_xor_b32 v13, s6, v13
    v_xor_b32 v14, s6, v14
    v_xor_b32 v15, s6, v15
    v_xor_b32 v16, s6, v16
    v_xor_b32 v20, s6, v20
    v_xor_b32 v24, s6, v24
    v_xor_b32 v28, s6, v28
    v_or3_b32 v32, v8, v9, v10
    v_or3_b32 v32, v11, v12, v32
    v_or3_b32 v32, v13, v14, v32
    v_or3_b32 v32, v15, v16, v32
    v_or3_b32 v32, v20, v24, v32
    v_or_b32 v32, v28, v32
    v_and_b32 v32, 0xfff, v32
    v_cmp_ne_u32 vcc, 0, v32
    s_cbranch_vccz Lgot_19
    s_add_u32 s59, s59, 1
    s_cmp_lt_u32 s59, 0x100000
    s_cbranch_scc1 Lpoll_18
    s_endpgm
Lgot_19:
    v_max_f32 v32, v8, v12
    v_mov_b32 v33, v32
    s_nop 1
    v_permlane16_swap_b32 v33, v32
    v_max_f32 v32, v32, v33
    v_mov_b32 v33, v32
    s_nop 1
    v_permlane32_swap_b32 v33, v32
    v_max_f32 v32, v32, v33
    v_sub_f32 v8, v8, v32
    v_sub_f32 v12, v12, v32
    v_mul_f32 v8, s71, v8
    v_mul_f32 v12, s71, v12
    v_exp_f32 v8, v8
    v_exp_f32 v12, v12
    s_nop 0
    v_mul_f32 v33, v8, v10
    v_mul_f32 v16, v8, v16
    v_mul_f32 v17, v8, v17
    v_mul_f32 v18, v8, v18
    v_mul_f32 v19, v8, v19
    v_fmac_f32 v33, v12, v14
    v_mul_f32 v20, v8, v20
    v_mul_f32 v21, v8, v21
    v_mul_f32 v22, v8, v22
    v_mul_f32 v23, v8, v23
    v_mov_b32 v34, v33
    v_fmac_f32 v16, v12, v24
    v_fmac_f32 v17, v12, v25
    v_fmac_f32 v18, v12, v26
    v_fmac_f32 v19, v12, v27
    v_fmac_f32 v20, v12, v28
    v_fmac_f32 v21, v12, v29
    v_fmac_f32 v22, v12, v30
    v_fmac_f32 v23, v12, v31
    v_permlane16_swap_b32 v34, v33
    v_permlane16_swap_b32 v16, v17
    v_permlane16_swap_b32 v18, v19
    v_permlane16_swap_b32 v20, v21
    v_permlane16_swap_b32 v22, v23
    v_add_f32 v33, v33, v34
    v_add_f32 v16, v16, v17
    v_add_f32 v18, v18, v19
    v_add_f32 v20, v20, v21
    v_add_f32 v22, v22, v23
    v_mov_b32 v34, v33
    v_permlane32_swap_b32 v16, v18
    v_permlane32_swap_b32 v20, v22
    v_permlane32_swap_b32 v34, v33
    v_add_f32 v16, v16, v18
    v_add_f32 v20, v20, v22
    v_add_f32 v33, v33, v34
    v_rcp_f32 v33, v33
    s_nop 0
    v_mul_f32 v16, v16, v33
    v_mul_f32 v20, v20, v33
    v_cvt_pk_bf16_f32 v16, v16, v20
    ds_write_b16 v2, v16
    ds_write_b16_d16_hi v2, v16 offset:128
    s_waitcnt lgkmcnt(0)
    s_barrier
    ds_read_b128 v[64:67], v49 offset:0
    ds_read_b128 v[68:71], v49 offset:64
    ds_read_b128 v[72:75], v49 offset:128
    ds_read_b128 v[76:79], v49 offset:192
    ds_read_b128 v[80:83], v49 offset:256
    ds_read_b128 v[84:87], v49 offset:320
    ds_read_b128 v[88:91], v49 offset:384
    ds_read_b128 v[92:95], v49 offset:448
    ds_read_b128 v[96:99], v49 offset:512
    ds_read_b128 v[100:103], v49 offset:576
    ds_read_b128 v[104:107], v49 offset:640
    ds_read_b128 v[108:111], v49 offset:704
    s_waitcnt lgkmcnt(11)
    v_mfma_f32_16x16x32_bf16 v[52:55], v[128:131], v[64:67], 0
    ds_read_b128 v[64:67], v49 offset:768
    s_waitcnt lgkmcnt(11)
    v_mfma_f32_16x16x32_bf16 v[52:55], v[132:135], v[68:71], v[52:55]
    ds_read_b128 v[68:71], v49 offset:832
    s_waitcnt lgkmcnt(11)
    v_mfma_f32_16x16x32_bf16 v[52:55], v[136:139], v[72:75], v[52:55]
    ds_read_b128 v[72:75], v49 offset:896
    s_waitcnt lgkmcnt(11)
    v_mfma_f32_16x16x32_bf16 v[52:55], v[140:143], v[76:79], v[52:55]
    ds_read_b128 v[76:79], v49 offset:960
    s_waitcnt lgkmcnt(11)
    v_mfma_f32_16x16x32_bf16 v[52:55], v[144:147], v[80:83], v[52:55]
    s_waitcnt lgkmcnt(10)
    v_mfma_f32_16x16x32_bf16 v[52:55], v[148:151], v[84:87], v[52:55]
    s_waitcnt lgkmcnt(9)
    v_mfma_f32_16x16x32_bf16 v[52:55], v[152:155], v[88:91], v[52:55]
    s_waitcnt lgkmcnt(8)
    v_mfma_f32_16x16x32_bf16 v[52:55], v[156:159], v[92:95], v[52:55]
    s_waitcnt lgkmcnt(7)
    v_mfma_f32_16x16x32_bf16 v[52:55], v[160:163], v[96:99], v[52:55]
    s_cmp_eq_u32 s65, 1
    s_cbranch_scc0 Lwo_nohu
    s_mov_b64 exec, 1
    global_store_dword v38, v39, s[34:35] sc1
    s_mov_b64 exec, -1
Lwo_nohu:
    s_waitcnt lgkmcnt(6)
    v_mfma_f32_16x16x32_bf16 v[52:55], v[164:167], v[100:103], v[52:55]
    s_waitcnt lgkmcnt(5)
    v_mfma_f32_16x16x32_bf16 v[52:55], v[168:171], v[104:107], v[52:55]
    s_waitcnt lgkmcnt(4)
    v_mfma_f32_16x16x32_bf16 v[52:55], v[172:175], v[108:111], v[52:55]
    s_waitcnt lgkmcnt(3)
    v_mfma_f32_16x16x32_bf16 v[52:55], v[176:179], v[64:67], v[52:55]
    s_waitcnt lgkmcnt(2)
    v_mfma_f32_16x16x32_bf16 v[52:55], v[180:183], v[68:71], v[52:55]
    s_waitcnt lgkmcnt(1)
    v_mfma_f32_16x16x32_bf16 v[52:55], v[184:187], v[72:75], v[52:55]
    s_waitcnt lgkmcnt(0)
    v_mfma_f32_16x16x32_bf16 v[52:55], v[188:191], v[76:79], v[52:55]
    s_nop 7
    v_add_u32 v52, 0x800, v52
    v_and_or_b32 v52, v52, v47, s6
    s_mov_b32 exec_lo, 0x00010001
    s_mov_b32 exec_hi, 0x00010001
    global_store_dwordx4 v45, v[52:55], s[34:35] sc1
    s_branch Lexit
Lt_ffn:
    s_cmp_lt_u32 s3, 4
    s_cbranch_scc0 Lf_help
    s_cmp_lt_u32 s3, 3
    s_cbranch_scc0 Lf_b4
    s_lshl_b32 s56, s3, 6
    v_add_u32 v2, s56, v0
    v_cmp_gt_u32 vcc, 144, v2
    s_nop 0
    s_mov_b64 s[72:73], vcc
    v_min_u32 v2, 143, v2
    v_lshlrev_b32 v3, 4, v2
    v_add_u32 v4, 114048, v3
    ds_read_b128 v[20:23], v4
    ds_read_b128 v[12:15], v4 offset:2304
    ds_read_b128 v[24:27], v4 offset:4608
    v_lshlrev_b32 v4, 3, v2
    v_add_u32 v4, 160448, v4
    v_add_u32 v5, 458752, v3
    v_add_u32 v6, 4608, v5
    v_add_u32 v7, 9216, v5
    v_add_u32 v8, 13824, v5
    v_and_b32 v60, 7, v0
    s_lshl_b32 s56, s4, 3
    v_add_u32 v60, s56, v60
    v_lshlrev_b32 v60, 7, v60
    v_add_u32 v60, 892928, v60
    s_lshl_b32 s56, s3, 3
    s_add_u32 s56, s56, 113984
    v_mov_b32 v10, s56
    s_waitcnt lgkmcnt(0)
    s_or_b32 s62, s6, 0x5a5a5000
    s_mov_b32 s59, 0
Lhu_20:
    global_load_dword v61, v60, s[34:35] sc1
    s_waitcnt vmcnt(0)
    v_cmp_ne_u32 vcc, s62, v61
    s_cbranch_vccz Lhud_21
    s_add_u32 s59, s59, 1
    s_cmp_lt_u32 s59, 0x100000
    s_cbranch_scc1 Lhu_20
    s_endpgm
Lhud_21:
    s_mov_b32 s59, 0
Lpoll_22:
    global_load_dwordx4 v[32:35], v5, s[34:35] offset:0 sc1
    global_load_dwordx4 v[36:39], v5, s[34:35] offset:2304 sc1
    global_load_dwordx4 v[40:43], v6, s[34:35] offset:0 sc1
    global_load_dwordx4 v[44:47], v6, s[34:35] offset:2304 sc1
    global_load_dwordx4 v[48:51], v7, s[34:35] offset:0 sc1
    global_load_dwordx4 v[52:55], v7, s[34:35] offset:2304 sc1
    global_load_dwordx4 v[56:59], v8, s[34:35] offset:0 sc1
    global_load_dwordx4 v[60:63], v8, s[34:35] offset:2304 sc1
    s_waitcnt vmcnt(0)
    v_xor_b32 v32, s6, v32
    v_xor_b32 v36, s6, v36
    v_xor_b32 v40, s6, v40
    v_xor_b32 v44, s6, v44
    v_xor_b32 v48, s6, v48
    v_xor_b32 v52, s6, v52
    v_xor_b32 v56, s6, v56
    v_xor_b32 v60, s6, v60
    v_or3_b32 v9, v32, v36, v40
    v_or3_b32 v9, v44, v48, v9
    v_or3_b32 v9, v52, v56, v9
    v_or_b32 v9, v60, v9
    v_and_b32 v9, 0xfff, v9
    v_cmp_ne_u32 vcc, 0, v9
    s_cbranch_vccz Lgot_23
    s_add_u32 s59, s59, 1
    s_cmp_lt_u32 s59, 0x100000
    s_cbranch_scc1 Lpoll_22
    s_endpgm
Lgot_23:
    v_pk_add_f32 v[32:33], v[32:33], v[36:37]
    v_pk_add_f32 v[34:35], v[34:35], v[38:39]
    v_pk_add_f32 v[40:41], v[40:41], v[44:45]
    v_pk_add_f32 v[42:43], v[42:43], v[46:47]
    v_pk_add_f32 v[48:49], v[48:49], v[52:53]
    v_pk_add_f32 v[50:51], v[50:51], v[54:55]
    v_pk_add_f32 v[56:57], v[56:57], v[60:61]
    v_pk_add_f32 v[58:59], v[58:59], v[62:63]
    v_pk_add_f32 v[32:33], v[32:33], v[40:41]
    v_pk_add_f32 v[34:35], v[34:35], v[42:43]
    v_pk_add_f32 v[48:49], v[48:49], v[56:57]
    v_pk_add_f32 v[50:51], v[50:51], v[58:59]
    v_pk_add_f32 v[32:33], v[32:33], v[48:49]
    v_pk_add_f32 v[34:35], v[34:35], v[50:51]
    v_pk_fma_f32 v[28:29], v[12:13], v[32:33], v[24:25]
    v_pk_fma_f32 v[30:31], v[14:15], v[34:35], v[26:27]
    v_pk_mul_f32 v[32:33], v[28:29], v[20:21]
    v_pk_mul_f32 v[34:35], v[30:31], v[22:23]
    v_cvt_pk_bf16_f32 v32, v32, v33
    v_cvt_pk_bf16_f32 v33, v34, v35
    s_mov_b64 exec, s[72:73]
    ds_write_b64 v4, v[32:33]
    s_mov_b64 exec, -1
    s_waitcnt lgkmcnt(0)
    s_barrier
    v_add_f32 v36, v28, v29
    v_add_f32 v38, v30, v31
    v_mul_f32 v37, v28, v28
    v_mul_f32 v39, v29, v29
    v_add_f32 v36, v36, v38
    v_fmac_f32 v37, v30, v30
    v_fmac_f32 v39, v31, v31
    v_add_f32 v37, v37, v39
    v_cndmask_b32 v36, 0, v36, s[72:73]
    v_cndmask_b32 v37, 0, v37, s[72:73]
    s_nop 0
    v_add_f32_dpp v36, v36, v36 row_ror:8 row_mask:0xf bank_mask:0xf
    v_add_f32_dpp v37, v37, v37 row_ror:8 row_mask:0xf bank_mask:0xf
    s_nop 0
    v_add_f32_dpp v36, v36, v36 row_ror:4 row_mask:0xf bank_mask:0xf
    v_add_f32_dpp v37, v37, v37 row_ror:4 row_mask:0xf bank_mask:0xf
    s_nop 0
    v_add_f32_dpp v36, v36, v36 row_ror:2 row_mask:0xf bank_mask:0xf
    v_add_f32_dpp v37, v37, v37 row_ror:2 row_mask:0xf bank_mask:0xf
    s_nop 0
    v_add_f32_dpp v36, v36, v36 row_ror:1 row_mask:0xf bank_mask:0xf
    v_add_f32_dpp v37, v37, v37 row_ror:1 row_mask:0xf bank_mask:0xf
    v_mov_b32 v38, v36
    v_mov_b32 v39, v37
    s_nop 0
    v_permlane16_swap_b32 v38, v36
    v_permlane16_swap_b32 v39, v37
    v_add_f32 v36, v36, v38
    v_add_f32 v37, v37, v39
    v_mov_b32 v38, v36
    v_mov_b32 v39, v37
    s_nop 0
    v_permlane32_swap_b32 v38, v36
    v_permlane32_swap_b32 v39, v37
    v_add_f32 v36, v36, v38
    v_add_f32 v37, v37, v39
    s_mov_b64 exec, 1
    ds_write_b64 v10, v[36:37]
    s_mov_b64 exec, -1
    s_branch Lf_vset
Lf_b4:
    s_barrier
Lf_vset:
    v_lshrrev_b32 v44, 4, v0
    s_lshl_b32 s56, s3, 12
    s_add_u32 s56, s56, 73728
    v_lshrrev_b32 v47, 4, v0
    v_bfe_u32 v45, v0, 2, 2
    v_lshl_add_u32 v46, v47, 3, v45
    v_lshlrev_b32 v46, 7, v46
    v_and_b32 v47, 1, v47
    v_lshrrev_b32 v45, 1, v45
    v_lshl_or_b32 v45, v47, 1, v45
    v_lshlrev_b32 v45, 5, v45
    v_and_b32 v47, 3, v0
    v_lshl_add_u32 v46, v47, 3, v46
    v_add_u32 v46, s56, v46
    v_xor_b32 v47, 0, v45
    v_add_u32 v60, v46, v47
    v_xor_b32 v47, 32, v45
    v_add_u32 v61, v46, v47
    v_xor_b32 v47, 64, v45
    v_add_u32 v62, v46, v47
    v_xor_b32 v47, 96, v45
    v_add_u32 v63, v46, v47
    s_and_b32 s57, s3, 3
    s_lshl_b32 s57, s57, 5
    v_xor_b32 v47, s57, v45
    v_add_u32 v47, v46, v47
    s_lshl_b32 s57, s3, 12
    s_sub_u32 s57, 32768, s57
    v_add_u32 v43, s57, v47
    v_and_b32 v40, 15, v0
    v_lshl_add_u32 v40, v44, 2, v40
    v_and_b32 v40, 15, v40
    v_lshlrev_b32 v41, 3, v40
    v_add_u32 v41, 112704, v41
    v_mov_b32 v42, 113984
    v_and_b32 v39, 15, v0
    v_cmp_eq_u32 s[66:67], 1, v39
    v_cmp_eq_u32 s[68:69], 2, v39
    v_cmp_eq_u32 s[70:71], 3, v39
    v_cmp_eq_u32 s[72:73], 4, v39
    s_lshl_b32 s56, s3, 2
    v_add_u32 v38, s56, v39
    s_add_u32 s56, s3, 32
    v_mov_b32 v37, s56
    v_cndmask_b32 v38, v38, v37, s[72:73]
    v_mul_u32_u24 v38, 9216, v38
    v_lshl_add_u32 v38, v44, 4, v38
    s_mul_i32 s59, s4, 18
    s_add_u32 s59, s59, s100
    s_lshl_b32 s59, s59, 6
    s_add_u32 s59, s59, 499712
    v_add_u32 v38, s59, v38
    v_mov_b32 v37, 0xfffff000
    s_movk_i32 s56, 4
    s_cmp_lt_u32 s3, 4
    s_cselect_b32 s56, 5, s56
    v_cmp_gt_u32 s[74:75], s56, v39
    s_mul_i32 s56, s4, 18
    s_add_u32 s56, s56, s100
    s_lshl_b32 s56, s56, 7
    s_add_u32 s56, s56, 868352
    v_mov_b32 v34, s56
    s_or_b32 s57, s6, 0x5a5a5000
    v_mov_b32 v35, s57
    s_waitcnt lgkmcnt(0)
    s_branch Lf_b5
Lf_help:
    s_sub_u32 s58, s3, 4
    s_mul_i32 s59, s4, 18
    s_add_u32 s59, s59, s100
    v_and_b32 v7, 1, v0
    v_bfe_u32 v8, v0, 1, 2
    v_bfe_u32 v9, v0, 4, 1
    v_xor_b32 v8, v8, v9
    s_and_b32 s57, s58, 1
    s_lshl_b32 s57, s57, 1
    v_xor_b32 v8, s57, v8
    v_lshlrev_b32 v8, 5, v8
    v_lshl_add_u32 v8, v7, 4, v8
    v_lshrrev_b32 v9, 3, v0
    s_movk_i32 s61, 1152
    v_mul_lo_u32 v9, v9, s61
    v_add_u32 v9, v9, v8
    s_mov_b32 s36, s24
    s_and_b32 s37, s25, 0xffff
    s_mov_b32 s38, 5308416
    s_mov_b32 s39, 0x20000
    s_mul_i32 s60, s59, 36864
    s_mul_i32 s61, s58, 9216
    s_add_u32 s60, s60, s61
    s_lshl_b32 s62, s58, 10
    s_add_u32 s62, s62, 73728
    s_mov_b32 m0, s62
    s_nop 0
    buffer_load_dwordx4 v9, s[36:39], s60 offen nt lds
    s_add_u32 s62, s62, 4096
    s_add_u32 s60, s60, 128
    s_mov_b32 m0, s62
    s_nop 0
    buffer_load_dwordx4 v9, s[36:39], s60 offen nt lds
    s_add_u32 s62, s62, 4096
    s_add_u32 s60, s60, 128
    s_mov_b32 m0, s62
    s_nop 0
    buffer_load_dwordx4 v9, s[36:39], s60 offen nt lds
    s_add_u32 s62, s62, 4096
    s_add_u32 s60, s60, 128
    s_mov_b32 m0, s62
    s_nop 0
    buffer_load_dwordx4 v9, s[36:39], s60 offen nt lds
    s_add_u32 s62, s62, 4096
    s_add_u32 s60, s60, 128
    s_mov_b32 m0, s62
    s_nop 0
    buffer_load_dwordx4 v9, s[36:39], s60 offen nt lds
    s_add_u32 s62, s62, 4096
    s_add_u32 s60, s60, 128
    s_mov_b32 m0, s62
    s_nop 0
    buffer_load_dwordx4 v9, s[36:39], s60 offen nt lds
    s_add_u32 s62, s62, 4096
    s_add_u32 s60, s60, 128
    s_mov_b32 m0, s62
    s_nop 0
    buffer_load_dwordx4 v9, s[36:39], s60 offen nt lds
    s_add_u32 s62, s62, 4096
    s_add_u32 s60, s60, 128
    s_mov_b32 m0, s62
    s_nop 0
    buffer_load_dwordx4 v9, s[36:39], s60 offen nt lds
    s_add_u32 s62, s62, 4096
    s_add_u32 s60, s60, 128
    s_mov_b32 m0, s62
    s_nop 0
    buffer_load_dwordx4 v9, s[36:39], s60 offen nt lds
    s_add_u32 s62, s62, 4096
    s_add_u32 s60, s60, 128
    v_lshrrev_b32 v28, 4, v0
    v_bfe_u32 v30, v0, 2, 2
    v_lshl_add_u32 v30, v28, 3, v30
    v_lshlrev_b32 v30, 6, v30
    v_and_b32 v29, 3, v0
    v_lshl_add_u32 v30, v29, 3, v30
    v_and_b32 v29, 1, v28
    s_and_b32 s56, s3, 1
    v_xor_b32 v29, s56, v29
    v_lshl_add_u32 v30, v29, 5, v30
    s_bfe_u32 s57, s3, 0x10001
    s_mul_i32 s57, s57, 36864
    v_add_u32 v30, s57, v30
    ds_read_b64_tr_b16 v[128:129], v30 offset:0
    ds_read_b64_tr_b16 v[130:131], v30 offset:256
    ds_read_b64_tr_b16 v[132:133], v30 offset:2048
    ds_read_b64_tr_b16 v[134:135], v30 offset:2304
    ds_read_b64_tr_b16 v[136:137], v30 offset:4096
    ds_read_b64_tr_b16 v[138:139], v30 offset:4352
    ds_read_b64_tr_b16 v[140:141], v30 offset:6144
    ds_read_b64_tr_b16 v[142:143], v30 offset:6400
    ds_read_b64_tr_b16 v[144:145], v30 offset:8192
    ds_read_b64_tr_b16 v[146:147], v30 offset:8448
    ds_read_b64_tr_b16 v[148:149], v30 offset:10240
    ds_read_b64_tr_b16 v[150:151], v30 offset:10496
    s_waitcnt lgkmcnt(2)
    ds_read_b64_tr_b16 v[152:153], v30 offset:12288
    ds_read_b64_tr_b16 v[154:155], v30 offset:12544
    ds_read_b64_tr_b16 v[156:157], v30 offset:14336
    ds_read_b64_tr_b16 v[158:159], v30 offset:14592
    ds_read_b64_tr_b16 v[160:161], v30 offset:16384
    ds_read_b64_tr_b16 v[162:163], v30 offset:16640
    ds_read_b64_tr_b16 v[164:165], v30 offset:18432
    ds_read_b64_tr_b16 v[166:167], v30 offset:18688
    ds_read_b64_tr_b16 v[168:169], v30 offset:20480
    ds_read_b64_tr_b16 v[170:171], v30 offset:20736
    s_waitcnt lgkmcnt(2)
    ds_read_b64_tr_b16 v[172:173], v30 offset:22528
    ds_read_b64_tr_b16 v[174:175], v30 offset:22784
    ds_read_b64_tr_b16 v[176:177], v30 offset:24576
    ds_read_b64_tr_b16 v[178:179], v30 offset:24832
    ds_read_b64_tr_b16 v[180:181], v30 offset:26624
    ds_read_b64_tr_b16 v[182:183], v30 offset:26880
    ds_read_b64_tr_b16 v[184:185], v30 offset:28672
    ds_read_b64_tr_b16 v[186:187], v30 offset:28928
    ds_read_b64_tr_b16 v[188:189], v30 offset:30720
    ds_read_b64_tr_b16 v[190:191], v30 offset:30976
    s_waitcnt lgkmcnt(2)
    ds_read_b64_tr_b16 v[192:193], v30 offset:32768
    ds_read_b64_tr_b16 v[194:195], v30 offset:33024
    ds_read_b64_tr_b16 v[196:197], v30 offset:34816
    ds_read_b64_tr_b16 v[198:199], v30 offset:35072
    v_and_b32 v32, 15, v0
    v_mov_b32 v31, 160448
    v_mov_b32 v33, 120960
    v_cmp_eq_u32 vcc, 1, v32
    s_nop 1
    v_cndmask_b32 v31, v31, v33, vcc
    v_mov_b32 v33, 122112
    v_cmp_eq_u32 vcc, 2, v32
    s_nop 1
    v_cndmask_b32 v31, v31, v33, vcc
    v_lshl_add_u32 v31, v28, 4, v31
    s_bfe_u32 s57, s3, 0x10001
    s_mul_i32 s57, s57, 384
    s_lshl_b32 s56, s56, 6
    s_add_u32 s57, s57, s56
    s_add_u32 s57, s57, 112704
    v_lshlrev_b32 v29, 7, v32
    v_lshl_add_u32 v29, v28, 4, v29
    v_add_u32 v29, s57, v29
    v_lshrrev_b32 v44, 4, v0
    s_lshl_b32 s56, s3, 12
    s_add_u32 s56, s56, 73728
    v_lshrrev_b32 v47, 4, v0
    v_bfe_u32 v45, v0, 2, 2
    v_lshl_add_u32 v46, v47, 3, v45
    v_lshlrev_b32 v46, 7, v46
    v_and_b32 v47, 1, v47
    v_lshrrev_b32 v45, 1, v45
    v_lshl_or_b32 v45, v47, 1, v45
    v_lshlrev_b32 v45, 5, v45
    v_and_b32 v47, 3, v0
    v_lshl_add_u32 v46, v47, 3, v46
    v_add_u32 v46, s56, v46
    v_xor_b32 v47, 0, v45
    v_add_u32 v60, v46, v47
    v_xor_b32 v47, 32, v45
    v_add_u32 v61, v46, v47
    v_xor_b32 v47, 64, v45
    v_add_u32 v62, v46, v47
    v_xor_b32 v47, 96, v45
    v_add_u32 v63, v46, v47
    s_and_b32 s57, s3, 3
    s_lshl_b32 s57, s57, 5
    v_xor_b32 v47, s57, v45
    v_add_u32 v47, v46, v47
    s_lshl_b32 s57, s3, 12
    s_sub_u32 s57, 32768, s57
    v_add_u32 v43, s57, v47
    v_and_b32 v40, 15, v0
    v_lshl_add_u32 v40, v44, 2, v40
    v_and_b32 v40, 15, v40
    v_lshlrev_b32 v41, 3, v40
    v_add_u32 v41, 112704, v41
    v_mov_b32 v42, 113984
    v_and_b32 v39, 15, v0
    v_cmp_eq_u32 s[66:67], 1, v39
    v_cmp_eq_u32 s[68:69], 2, v39
    v_cmp_eq_u32 s[70:71], 3, v39
    v_cmp_eq_u32 s[72:73], 4, v39
    s_lshl_b32 s56, s3, 2
    v_add_u32 v38, s56, v39
    s_add_u32 s56, s3, 32
    v_mov_b32 v37, s56
    v_cndmask_b32 v38, v38, v37, s[72:73]
    v_mul_u32_u24 v38, 9216, v38
    v_lshl_add_u32 v38, v44, 4, v38
    s_mul_i32 s59, s4, 18
    s_add_u32 s59, s59, s100
    s_lshl_b32 s59, s59, 6
    s_add_u32 s59, s59, 499712
    v_add_u32 v38, s59, v38
    v_mov_b32 v37, 0xfffff000
    s_movk_i32 s56, 4
    s_cmp_lt_u32 s3, 4
    s_cselect_b32 s56, 5, s56
    v_cmp_gt_u32 s[74:75], s56, v39
    s_mul_i32 s56, s4, 18
    s_add_u32 s56, s56, s100
    s_lshl_b32 s56, s56, 7
    s_add_u32 s56, s56, 868352
    v_mov_b32 v34, s56
    s_or_b32 s57, s6, 0x5a5a5000
    v_mov_b32 v35, s57
    s_waitcnt lgkmcnt(0)
    s_barrier
    ds_read_b128 v[200:203], v31 offset:0
    ds_read_b128 v[204:207], v31 offset:64
    ds_read_b128 v[208:211], v31 offset:128
    ds_read_b128 v[212:215], v31 offset:192
    ds_read_b128 v[216:219], v31 offset:256
    ds_read_b128 v[220:223], v31 offset:320
    ds_read_b128 v[224:227], v31 offset:384
    ds_read_b128 v[228:231], v31 offset:448
    ds_read_b128 v[232:235], v31 offset:512
    ds_read_b128 v[236:239], v31 offset:576
    ds_read_b128 v[240:243], v31 offset:640
    ds_read_b128 v[244:247], v31 offset:704
    s_waitcnt lgkmcnt(11)
    v_mfma_f32_16x16x32_bf16 v[52:55], v[128:131], v[200:203], 0
    ds_read_b128 v[200:203], v31 offset:768
    s_waitcnt lgkmcnt(11)
    v_mfma_f32_16x16x32_bf16 v[52:55], v[132:135], v[204:207], v[52:55]
    ds_read_b128 v[204:207], v31 offset:832
    s_waitcnt lgkmcnt(11)
    v_mfma_f32_16x16x32_bf16 v[52:55], v[136:139], v[208:211], v[52:55]
    ds_read_b128 v[208:211], v31 offset:896
    s_waitcnt lgkmcnt(11)
    v_mfma_f32_16x16x32_bf16 v[52:55], v[140:143], v[212:215], v[52:55]
    ds_read_b128 v[212:215], v31 offset:960
    s_waitcnt lgkmcnt(11)
    v_mfma_f32_16x16x32_bf16 v[52:55], v[144:147], v[216:219], v[52:55]
    ds_read_b128 v[216:219], v31 offset:1024
    s_waitcnt lgkmcnt(11)
    v_mfma_f32_16x16x32_bf16 v[52:55], v[148:151], v[220:223], v[52:55]
    ds_read_b128 v[220:223], v31 offset:1088
    s_waitcnt lgkmcnt(11)
    v_mfma_f32_16x16x32_bf16 v[52:55], v[152:155], v[224:227], v[52:55]
    s_waitcnt lgkmcnt(10)
    v_mfma_f32_16x16x32_bf16 v[52:55], v[156:159], v[228:231], v[52:55]
    s_waitcnt lgkmcnt(9)
    v_mfma_f32_16x16x32_bf16 v[52:55], v[160:163], v[232:235], v[52:55]
    s_waitcnt lgkmcnt(8)
    v_mfma_f32_16x16x32_bf16 v[52:55], v[164:167], v[236:239], v[52:55]
    s_waitcnt lgkmcnt(7)
    v_mfma_f32_16x16x32_bf16 v[52:55], v[168:171], v[240:243], v[52:55]
    s_waitcnt lgkmcnt(6)
    v_mfma_f32_16x16x32_bf16 v[52:55], v[172:175], v[244:247], v[52:55]
    s_waitcnt lgkmcnt(5)
    v_mfma_f32_16x16x32_bf16 v[52:55], v[176:179], v[200:203], v[52:55]
    s_waitcnt lgkmcnt(4)
    v_mfma_f32_16x16x32_bf16 v[52:55], v[180:183], v[204:207], v[52:55]
    s_waitcnt lgkmcnt(3)
    v_mfma_f32_16x16x32_bf16 v[52:55], v[184:187], v[208:211], v[52:55]
    s_waitcnt lgkmcnt(2)
    v_mfma_f32_16x16x32_bf16 v[52:55], v[188:191], v[212:215], v[52:55]
    s_waitcnt lgkmcnt(1)
    v_mfma_f32_16x16x32_bf16 v[52:55], v[192:195], v[216:219], v[52:55]
    s_waitcnt lgkmcnt(0)
    v_mfma_f32_16x16x32_bf16 v[52:55], v[196:199], v[220:223], v[52:55]
    s_mov_b32 exec_lo, 0x00070007
    s_mov_b32 exec_hi, 0x00070007
    s_nop 5
    ds_write_b128 v29, v[52:55]
    s_mov_b64 exec, -1
    s_waitcnt vmcnt(0) lgkmcnt(0)
Lf_b5:
    s_barrier
    ds_read_b128 v[48:51], v42
    ds_read_b64 v[46:47], v42 offset:16
    ds_read_b64 v[84:85], v41
    ds_read_b64 v[86:87], v41 offset:128
    ds_read_b64 v[88:89], v41 offset:256
    ds_read_b64 v[90:91], v41 offset:384
    ds_read_b64 v[92:93], v41 offset:512
    ds_read_b64 v[94:95], v41 offset:640
    ds_read_b64_tr_b16 v[64:65], v60
    ds_read_b64_tr_b16 v[66:67], v60 offset:512
    ds_read_b64_tr_b16 v[68:69], v61
    ds_read_b64_tr_b16 v[70:71], v61 offset:512
    ds_read_b64_tr_b16 v[72:73], v62
    ds_read_b64_tr_b16 v[74:75], v62 offset:512
    s_waitcnt lgkmcnt(12)
    v_add_f32 v48, v48, v50
    v_add_f32 v49, v49, v51
    v_mov_b32 v50, 0x3ae38e39
    v_add_f32 v48, v48, v46
    v_add_f32 v49, v49, v47
    v_mul_f32 v48, v48, v50
    v_mul_f32 v49, v49, v50
    v_fma_f32 v49, -v48, v48, v49
    v_max_f32 v49, 0, v49
    v_add_f32 v49, 0x3727c5ac, v49
    v_rsq_f32 v49, v49
    s_waitcnt lgkmcnt(6)
    ds_read_b64_tr_b16 v[76:77], v63
    ds_read_b64_tr_b16 v[78:79], v63 offset:512
    ds_read_b64_tr_b16 v[80:81], v43
    ds_read_b64_tr_b16 v[82:83], v43 offset:512
    v_fma_f32 v84, -v48, v86, v84
    v_fma_f32 v85, -v48, v87, v85
    v_fma_f32 v90, -v48, v92, v90
    v_fma_f32 v91, -v48, v93, v91
    v_fma_f32 v84, v84, v49, v88
    v_fma_f32 v85, v85, v49, v89
    v_fma_f32 v90, v90, v49, v94
    v_fma_f32 v91, v91, v49, v95
    v_mul_f32 v86, 0xbfb8aa3b, v84
    v_mul_f32 v87, 0xbfb8aa3b, v85
    v_exp_f32 v86, v86
    v_exp_f32 v87, v87
    s_nop 0
    v_add_f32 v86, 1.0, v86
    v_add_f32 v87, 1.0, v87
    v_rcp_f32 v86, v86
    v_rcp_f32 v87, v87
    s_nop 0
    v_mul_f32 v86, v86, v90
    v_mul_f32 v87, v87, v91
    v_cvt_pk_bf16_f32 v86, v86, v87
    s_nop 1
    v_mov_b32_dpp v56, v86 row_newbcast:0 row_mask:0xf bank_mask:0xf
    v_mov_b32_dpp v57, v86 row_newbcast:1 row_mask:0xf bank_mask:0xf
    v_mov_b32_dpp v58, v86 row_newbcast:2 row_mask:0xf bank_mask:0xf
    v_mov_b32_dpp v59, v86 row_newbcast:3 row_mask:0xf bank_mask:0xf
    s_cmp_eq_u32 s3, 3
    s_cbranch_scc0 Lf_nohu
    s_mov_b64 exec, 1
    global_store_dword v34, v35, s[34:35] sc1
    s_mov_b64 exec, -1
Lf_nohu:
    s_waitcnt lgkmcnt(0)
    v_mfma_f32_16x16x32_bf16 v[96:99], v[64:67], v[56:59], 0
    v_mfma_f32_16x16x32_bf16 v[100:103], v[68:71], v[56:59], 0
    v_mfma_f32_16x16x32_bf16 v[104:107], v[72:75], v[56:59], 0
    v_mfma_f32_16x16x32_bf16 v[108:111], v[76:79], v[56:59], 0
    v_mfma_f32_16x16x32_bf16 v[112:115], v[80:83], v[56:59], 0
    s_nop 4
    v_cndmask_b32 v96, v96, v100, s[66:67]
    v_cndmask_b32 v97, v97, v101, s[66:67]
    v_cndmask_b32 v98, v98, v102, s[66:67]
    v_cndmask_b32 v99, v99, v103, s[66:67]
    v_cndmask_b32 v96, v96, v104, s[68:69]
    v_cndmask_b32 v97, v97, v105, s[68:69]
    v_cndmask_b32 v98, v98, v106, s[68:69]
    v_cndmask_b32 v99, v99, v107, s[68:69]
    v_cndmask_b32 v96, v96, v108, s[70:71]
    v_cndmask_b32 v97, v97, v109, s[70:71]
    v_cndmask_b32 v98, v98, v110, s[70:71]
    v_cndmask_b32 v99, v99, v111, s[70:71]
    v_cndmask_b32 v96, v96, v112, s[72:73]
    v_cndmask_b32 v97, v97, v113, s[72:73]
    v_cndmask_b32 v98, v98, v114, s[72:73]
    v_cndmask_b32 v99, v99, v115, s[72:73]
    v_add_u32 v96, 0x800, v96
    v_and_or_b32 v96, v96, v37, s6
    s_mov_b64 exec, s[74:75]
    global_store_dwordx4 v38, v[96:99], s[34:35] sc1
    s_branch Lexit
Lt_final:
    s_sub_u32 s56, s100, 27
    s_lshl_b32 s56, s56, 3
    s_add_u32 s74, s56, s4
    s_cmp_eq_u32 s3, 4
    s_cbranch_scc0 Lexit
Lz_fin:
    s_cmp_ge_u32 s74, 36
    s_cbranch_scc1 Lexit
    v_and_b32 v2, 3, v0
    s_lshl_b32 s56, s74, 2
    v_add_u32 v2, s56, v2
    v_lshlrev_b32 v3, 4, v2
    v_lshlrev_b32 v4, 3, v2
    v_add_u32 v5, 458752, v3
    v_add_u32 v6, 4608, v5
    v_add_u32 v7, 9216, v5
    v_add_u32 v8, 13824, v5
    v_and_b32 v60, 7, v0
    s_lshl_b32 s56, s4, 3
    v_add_u32 v60, s56, v60
    v_lshlrev_b32 v60, 7, v60
    v_add_u32 v60, 892928, v60
    s_or_b32 s62, s6, 0x5a5a5000
    s_mov_b32 s59, 0
Lhu_24:
    global_load_dword v61, v60, s[34:35] sc1
    s_waitcnt vmcnt(0)
    v_cmp_ne_u32 vcc, s62, v61
    s_cbranch_vccz Lhud_25
    s_add_u32 s59, s59, 1
    s_cmp_lt_u32 s59, 0x100000
    s_cbranch_scc1 Lhu_24
    s_endpgm
Lhud_25:
    s_mov_b32 s59, 0
Lpoll_26:
    global_load_dwordx4 v[32:35], v5, s[34:35] offset:0 sc1
    global_load_dwordx4 v[36:39], v5, s[34:35] offset:2304 sc1
    global_load_dwordx4 v[40:43], v6, s[34:35] offset:0 sc1
    global_load_dwordx4 v[44:47], v6, s[34:35] offset:2304 sc1
    global_load_dwordx4 v[48:51], v7, s[34:35] offset:0 sc1
    global_load_dwordx4 v[52:55], v7, s[34:35] offset:2304 sc1
    global_load_dwordx4 v[56:59], v8, s[34:35] offset:0 sc1
    global_load_dwordx4 v[60:63], v8, s[34:35] offset:2304 sc1
    s_waitcnt vmcnt(0)
    v_xor_b32 v32, s6, v32
    v_xor_b32 v36, s6, v36
    v_xor_b32 v40, s6, v40
    v_xor_b32 v44, s6, v44
    v_xor_b32 v48, s6, v48
    v_xor_b32 v52, s6, v52
    v_xor_b32 v56, s6, v56
    v_xor_b32 v60, s6, v60
    v_or3_b32 v9, v32, v36, v40
    v_or3_b32 v9, v44, v48, v9
    v_or3_b32 v9, v52, v56, v9
    v_or_b32 v9, v60, v9
    v_and_b32 v9, 0xfff, v9
    v_cmp_ne_u32 vcc, 0, v9
    s_cbranch_vccz Lgot_27
    s_add_u32 s59, s59, 1
    s_cmp_lt_u32 s59, 0x100000
    s_cbranch_scc1 Lpoll_26
    s_endpgm
Lgot_27:
    v_pk_add_f32 v[32:33], v[32:33], v[36:37]
    v_pk_add_f32 v[34:35], v[34:35], v[38:39]
    v_pk_add_f32 v[40:41], v[40:41], v[44:45]
    v_pk_add_f32 v[42:43], v[42:43], v[46:47]
    v_pk_add_f32 v[48:49], v[48:49], v[52:53]
    v_pk_add_f32 v[50:51], v[50:51], v[54:55]
    v_pk_add_f32 v[56:57], v[56:57], v[60:61]
    v_pk_add_f32 v[58:59], v[58:59], v[62:63]
    v_pk_add_f32 v[32:33], v[32:33], v[40:41]
    v_pk_add_f32 v[34:35], v[34:35], v[42:43]
    v_pk_add_f32 v[48:49], v[48:49], v[56:57]
    v_pk_add_f32 v[50:51], v[50:51], v[58:59]
    v_pk_add_f32 v[32:33], v[32:33], v[48:49]
    v_pk_add_f32 v[34:35], v[34:35], v[50:51]
    v_pk_fma_f32 v[28:29], v[12:13], v[32:33], v[24:25]
    v_pk_fma_f32 v[30:31], v[14:15], v[34:35], v[26:27]
    v_lshlrev_b32 v5, 4, v0
    s_mul_i32 s56, s74, 9216
    s_add_u32 s56, s56, 499712
    v_add_u32 v5, s56, v5
    v_add_u32 v70, 0, v5
    v_add_u32 v71, 1024, v5
    v_add_u32 v72, 2048, v5
    v_add_u32 v73, 3072, v5
    v_add_u32 v74, 4096, v5
    v_add_u32 v75, 5120, v5
    v_add_u32 v76, 6144, v5
    v_add_u32 v77, 7168, v5
    v_add_u32 v78, 8192, v5
    v_lshrrev_b32 v60, 4, v0
    v_cmp_eq_u32 s[66:67], 1, v60
    v_cmp_eq_u32 s[68:69], 2, v60
    v_cmp_eq_u32 s[70:71], 3, v60
    v_lshl_add_u32 v4, v60, 1, v4
    v_cndmask_b32 v16, v16, v17, s[66:67]
    v_cndmask_b32 v28, v28, v29, s[66:67]
    v_cndmask_b32 v16, v16, v18, s[68:69]
    v_cndmask_b32 v28, v28, v30, s[68:69]
    v_cndmask_b32 v16, v16, v19, s[70:71]
    v_cndmask_b32 v28, v28, v31, s[70:71]
    s_cmp_ge_u32 s74, 18
    s_cselect_b32 s56, 18, 0
    s_sub_u32 s56, s74, s56
    v_and_b32 v60, 7, v0
    v_mul_u32_u24 v60, 18, v60
    v_add_u32 v60, s56, v60
    v_lshlrev_b32 v60, 7, v60
    v_add_u32 v60, 868352, v60
    s_or_b32 s62, s6, 0x5a5a5000
    s_mov_b32 s59, 0
Lz_hu:
    global_load_dword v61, v60, s[34:35] sc1
    s_waitcnt vmcnt(0)
    v_cmp_ne_u32 vcc, s62, v61
    s_cbranch_vccz Lz_hud
    s_add_u32 s59, s59, 1
    s_cmp_lt_u32 s59, 0x100000
    s_cbranch_scc1 Lz_hu
    s_endpgm
Lz_hud:
    s_mov_b32 s59, 0
Lpoll_28:
    global_load_dwordx4 v[32:35], v70, s[34:35] sc1
    global_load_dwordx4 v[36:39], v71, s[34:35] sc1
    global_load_dwordx4 v[40:43], v72, s[34:35] sc1
    global_load_dwordx4 v[44:47], v73, s[34:35] sc1
    global_load_dwordx4 v[48:51], v74, s[34:35] sc1
    global_load_dwordx4 v[52:55], v75, s[34:35] sc1
    global_load_dwordx4 v[56:59], v76, s[34:35] sc1
    global_load_dwordx4 v[60:63], v77, s[34:35] sc1
    global_load_dwordx4 v[64:67], v78, s[34:35] sc1
    s_waitcnt vmcnt(0)
    v_xor_b32 v32, s6, v32
    v_xor_b32 v36, s6, v36
    v_xor_b32 v40, s6, v40
    v_xor_b32 v44, s6, v44
    v_xor_b32 v48, s6, v48
    v_xor_b32 v52, s6, v52
    v_xor_b32 v56, s6, v56
    v_xor_b32 v60, s6, v60
    v_xor_b32 v64, s6, v64
    v_or3_b32 v7, v32, v36, v40
    v_or3_b32 v7, v44, v48, v7
    v_or3_b32 v7, v52, v56, v7
    v_or3_b32 v7, v60, v64, v7
    v_and_b32 v7, 0xfff, v7
    v_cmp_ne_u32 vcc, 0, v7
    s_cbranch_vccz Lgot_29
    s_add_u32 s59, s59, 1
    s_cmp_lt_u32 s59, 0x100000
    s_cbranch_scc1 Lpoll_28
    s_endpgm
Lgot_29:
    v_pk_add_f32 v[32:33], v[32:33], v[36:37]
    v_pk_add_f32 v[34:35], v[34:35], v[38:39]
    v_pk_add_f32 v[40:41], v[40:41], v[44:45]
    v_pk_add_f32 v[42:43], v[42:43], v[46:47]
    v_pk_add_f32 v[48:49], v[48:49], v[52:53]
    v_pk_add_f32 v[50:51], v[50:51], v[54:55]
    v_pk_add_f32 v[56:57], v[56:57], v[60:61]
    v_pk_add_f32 v[58:59], v[58:59], v[62:63]
    v_pk_add_f32 v[32:33], v[32:33], v[40:41]
    v_pk_add_f32 v[34:35], v[34:35], v[42:43]
    v_pk_add_f32 v[48:49], v[48:49], v[56:57]
    v_pk_add_f32 v[50:51], v[50:51], v[58:59]
    v_pk_add_f32 v[32:33], v[32:33], v[64:65]
    v_pk_add_f32 v[34:35], v[34:35], v[66:67]
    v_pk_add_f32 v[32:33], v[32:33], v[48:49]
    v_pk_add_f32 v[34:35], v[34:35], v[50:51]
    s_nop 0
    v_add_f32_dpp v32, v32, v32 row_ror:4 row_mask:0xf bank_mask:0xf
    v_add_f32_dpp v33, v33, v33 row_ror:4 row_mask:0xf bank_mask:0xf
    v_add_f32_dpp v34, v34, v34 row_ror:4 row_mask:0xf bank_mask:0xf
    v_add_f32_dpp v35, v35, v35 row_ror:4 row_mask:0xf bank_mask:0xf
    v_add_f32_dpp v32, v32, v32 row_ror:8 row_mask:0xf bank_mask:0xf
    v_add_f32_dpp v33, v33, v33 row_ror:8 row_mask:0xf bank_mask:0xf
    v_add_f32_dpp v34, v34, v34 row_ror:8 row_mask:0xf bank_mask:0xf
    v_add_f32_dpp v35, v35, v35 row_ror:8 row_mask:0xf bank_mask:0xf
    v_permlane16_swap_b32 v32, v33
    s_nop 0
    v_permlane16_swap_b32 v34, v35
    v_add_f32 v32, v32, v33
    v_add_f32 v34, v34, v35
    s_nop 1
    v_permlane32_swap_b32 v32, v34
    v_add_f32 v32, v32, v34
    v_fma_f32 v32, v32, v16, v28
    v_cvt_pk_bf16_f32 v32, v32, v32
    s_mov_b32 exec_lo, 0x000f000f
    s_mov_b32 exec_hi, 0x000f000f
    global_store_short v4, v32, s[30:31]
    s_cmp_eq_u32 s74, 0
    s_cbranch_scc0 Lz_done
    s_mov_b64 exec, 1
    v_mov_b32 v5, 0
    v_mov_b32 v6, s7
    global_store_dword v5, v6, s[34:35] sc1
Lz_done:
Lexit:
Lend:
    s_endpgm
Lcode_end:

.section .rodata,"a"
.p2align 6
.amdhsa_kernel adaLN_cond__mha_block_cached__glu_gated_glu__decode_kernel
  .amdhsa_next_free_vgpr 256
  .amdhsa_next_free_sgpr 102
  .amdhsa_accum_offset 256
  .amdhsa_group_segment_fixed_size 0
  .amdhsa_kernarg_size 112
  .amdhsa_user_sgpr_count 2
  .amdhsa_user_sgpr_kernarg_segment_ptr 1
  .amdhsa_system_sgpr_workgroup_id_x 1
.end_amdhsa_kernel
```
